```python
import torch

def _softmax(x, axis=-1):
    return torch.softmax(x, dim=axis)
def _gelu(x):
    return torch.nn.functional.gelu(x, approximate="tanh")
def _silu(x):
    return torch.nn.functional.silu(x)
def _sigmoid(x):
    return torch.sigmoid(x)
def _layernorm(x, axis=-1, eps=1e-5):
    m = x.mean(dim=axis, keepdim=True)
    v = x.var(dim=axis, keepdim=True, unbiased=False)
    return (x - m) / torch.sqrt(v + eps)
def _scatter_add(tgt, idx, src, axis=0):
    return tgt.clone().index_add_(axis, idx, src)
def _segment_sum(src, seg, n):
    out = torch.zeros((n,) + src.shape[1:], dtype=src.dtype)
    return out.index_add_(0, seg, src)
def _pad(x, pw):
    flat = tuple(v for pair in reversed(pw) for v in pair)
    return torch.nn.functional.pad(x, flat)

kernel_name = 'parallel_sum__softmax_full_mha__glu_gated_reglu__prompt'

def setup_inputs():

    _w = (lambda a: (lambda t: t.to(torch.bfloat16) if t.is_floating_point() else t)(torch.as_tensor(a)))
    def _A_setup():
        B, S, D = 1, 2048, 512
        return {
            "x": _w((lambda *s: torch.randn(*s, dtype=torch.bfloat16) * 0.05)(B, S, D)),
            "wqkv": _w((lambda *s: torch.randn(*s, dtype=torch.bfloat16) * 0.05)(D, 3 * D)),
            "wo": _w((lambda *s: torch.randn(*s, dtype=torch.bfloat16) * 0.05)(D, D)),
        }
    _A_in = _A_setup()

    def _B_setup():
        B, S, D, F = 1, 2048, 512, 1792
        return {
            "x": _w((lambda *s: torch.randn(*s, dtype=torch.bfloat16) * 0.05)(B, S, D)),
            "W_gate": _w((lambda *s: torch.randn(*s, dtype=torch.bfloat16) * 0.4)(D, F) * (2.0 / D) ** 0.5),
            "W_up": _w((lambda *s: torch.randn(*s, dtype=torch.bfloat16) * 0.4)(D, F) * (2.0 / D) ** 0.5),
            "W_down": _w((lambda *s: torch.randn(*s, dtype=torch.bfloat16) * 0.4)(F, D) * (1.0 / F) ** 0.5),
        }
    _B_in = _B_setup()

    return {
        "A_x": _A_in["x"],
        "A_wqkv": _A_in["wqkv"],
        "A_wo": _A_in["wo"],
        "B_x": _B_in["x"],
        "B_W_gate": _B_in["W_gate"],
        "B_W_up": _B_in["W_up"],
        "B_W_down": _B_in["W_down"],
    }

def reference(A_x, A_wqkv, A_wo, B_x, B_W_gate, B_W_up, B_W_down):
    def _A_ref(x, wqkv, wo):
        B, S, D = x.shape
        H = 32; Dh = D // H
        qkv = (lambda x, *d: x.permute(*d))((x @ wqkv).reshape(B, S, 3, H, Dh), 2, 0, 3, 1, 4)
        q, k, v = qkv[0], qkv[1], qkv[2]
        scale = Dh ** -0.5
        scores = torch.einsum("bhqd,bhkd->bhqk", q, k) * scale
        p = _softmax(scores, axis=-1)
        o = torch.einsum("bhqk,bhkd->bhqd", p, v)
        return (lambda x, *d: x.permute(*d))(o, 0, 2, 1, 3).reshape(B, S, D) @ wo

    def _B_ref(x, W_gate, W_up, W_down):
        gate = torch.einsum("bsd,df->bsf", x, W_gate)
        up = torch.einsum("bsd,df->bsf", x, W_up)
        gate = gate * (lambda x, dt: x.to(dt))(gate > 0, gate.dtype)
        h = gate * up
        return torch.einsum("bsf,fd->bsd", h, W_down)

    x = A_x
    xn = _layernorm(x, axis=-1)
    return x + _A_ref(xn, A_wqkv, A_wo) + _B_ref(xn, B_W_gate, B_W_up, B_W_down)
```

```asm
; @launch grid=(256,1,1) block=(512,1,1) lds=162304
.amdgcn_target "amdgcn-amd-amdhsa--gfx950"
.text
.globl parallel_sum__softmax_full_mha__glu_gated_reglu__prompt_kernel
.p2align 8
.type parallel_sum__softmax_full_mha__glu_gated_reglu__prompt_kernel,@function
parallel_sum__softmax_full_mha__glu_gated_reglu__prompt_kernel:
  s_cmp_ge_u32 s2, 256
  s_cbranch_scc1 L_exit
  s_load_dwordx16 s[4:19], s[0:1], 0
  s_load_dwordx4 s[20:23], s[0:1], 64
  v_lshrrev_b32 v1, 6, v0
  v_and_b32 v0, 63, v0
  v_readfirstlane_b32 s3, v1
  s_bfe_u32 s53, s2, 0x20001
  s_lshl_b32 s53, s53, 2
  s_bfe_u32 s54, s2, 0x20003
  s_or_b32 s53, s53, s54
  s_and_b32 s54, s2, 1
  s_lshl_b32 s54, s54, 3
  s_lshr_b32 s55, s2, 5
  s_or_b32 s54, s54, s55
  s_lshl_b32 s55, s53, 1
  s_add_u32 s55, s55, s54
  s_lshr_b32 s52, s53, 2
  s_add_u32 s55, s55, s52
  s_and_b32 s52, s3, 3
  s_mov_b32 s70, 0x40000
  s_cmp_lt_u32 s3, 4
  s_cbranch_scc1 L_G
  s_setprio 1
  v_lshrrev_b32 v1, 3, v0
  v_lshlrev_b32 v16, 10, v1
  v_lshrrev_b32 v17, 4, v0
  v_and_b32 v18, 7, v0
  v_xor_b32 v17, v17, v18
  v_lshl_add_u32 v2, v17, 4, v16
  v_xor_b32 v3, 64, v2
  v_add_u32 v3, 7168, v3
  v_bfe_u32 v17, v0, 4, 1
  v_bfe_u32 v19, v0, 2, 1
  v_xor_b32 v17, v17, v19
  v_mul_u32_u24 v16, 3072, v1
  v_lshl_add_u32 v16, v17, 10, v16
  v_and_b32 v18, 3, v0
  v_lshl_add_u32 v4, v18, 4, v16
  v_add_u32 v5, 23552, v4
  s_lshl_b32 s56, s53, 2
  s_add_u32 s56, s56, s52
  s_lshl_b32 s56, s56, 15
  s_add_u32 s57, s56, 14336
  s_lshl_b32 s59, s52, 12
  s_mul_i32 s58, s52, 49152
  s_lshl_b32 s3, s54, 6
  s_add_u32 s68, s58, s3
  s_add_u32 s58, s68, 1024
  s_waitcnt lgkmcnt(0)
  s_mov_b32 s24, s4
  s_mov_b32 s25, s5
  s_mov_b32 s26, 2097152
  s_mov_b32 s27, 0x20000
  s_mov_b32 s28, s6
  s_mov_b32 s29, s7
  s_mov_b32 s30, 1572864
  s_mov_b32 s31, 0x20000
  s_add_u32 s62, s55, 0
  s_and_b32 s62, s62, 7
  s_lshl_b32 s62, s62, 7
  s_add_u32 m0, s59, 0
  s_add_u32 s60, s56, s62
  s_add_u32 s61, s57, s62
  buffer_load_dwordx4 v2, s[24:27], s60 offen offset:0 lds
  buffer_load_dwordx4 v3, s[24:27], s60 offen offset:1024 lds
  buffer_load_dwordx4 v2, s[24:27], s61 offen offset:2048 lds
  buffer_load_dwordx4 v3, s[24:27], s61 offen offset:3072 lds
  s_add_u32 s62, s55, 0
  s_and_b32 s62, s62, 7
  s_mul_i32 s62, s62, 196608
  s_lshr_b32 s3, s59, 1
  s_add_u32 m0, s3, 16384
  s_add_u32 s60, s58, s62
  buffer_load_dwordx4 v4, s[28:31], s60 offen offset:0 lds
  buffer_load_dwordx4 v5, s[28:31], s60 offen offset:1024 lds
  s_add_u32 s62, s55, 1
  s_and_b32 s62, s62, 7
  s_mul_i32 s62, s62, 196608
  s_lshr_b32 s3, s59, 1
  s_add_u32 m0, s3, 40960
  s_add_u32 s60, s58, s62
  buffer_load_dwordx4 v4, s[28:31], s60 offen offset:0 lds
  buffer_load_dwordx4 v5, s[28:31], s60 offen offset:1024 lds
  s_add_u32 s62, s55, 1
  s_and_b32 s62, s62, 7
  s_lshl_b32 s62, s62, 7
  s_add_u32 m0, s59, 24576
  s_add_u32 s60, s56, s62
  s_add_u32 s61, s57, s62
  buffer_load_dwordx4 v2, s[24:27], s60 offen offset:0 lds
  buffer_load_dwordx4 v3, s[24:27], s60 offen offset:1024 lds
  buffer_load_dwordx4 v2, s[24:27], s61 offen offset:2048 lds
  buffer_load_dwordx4 v3, s[24:27], s61 offen offset:3072 lds
  s_mov_b32 s36, s22
  s_mov_b32 s37, s23
  s_mov_b32 s38, 18874368
  s_mov_b32 s39, 0x20000
  s_mov_b32 s72, s20
  s_mov_b32 s73, s21
  s_mov_b32 s74, 256
  s_mov_b32 s75, 0x20000
  v_lshrrev_b32 v16, 2, v0
  v_mul_u32_u24 v16, 3072, v16
  v_lshl_add_u32 v6, v18, 4, v16
  s_waitcnt vmcnt(6)
  s_barrier
  s_add_u32 s62, s55, 2
  s_and_b32 s62, s62, 7
  s_lshl_b32 s62, s62, 7
  s_add_u32 m0, s59, 49152
  s_add_u32 s60, s56, s62
  s_add_u32 s61, s57, s62
  buffer_load_dwordx4 v2, s[24:27], s60 offen offset:0 lds
  buffer_load_dwordx4 v3, s[24:27], s60 offen offset:1024 lds
  buffer_load_dwordx4 v2, s[24:27], s61 offen offset:2048 lds
  buffer_load_dwordx4 v3, s[24:27], s61 offen offset:3072 lds
  s_add_u32 s62, s55, 2
  s_and_b32 s62, s62, 7
  s_mul_i32 s62, s62, 196608
  s_lshr_b32 s3, s59, 1
  s_add_u32 m0, s3, 65536
  s_add_u32 s60, s58, s62
  buffer_load_dwordx4 v4, s[28:31], s60 offen offset:0 lds
  buffer_load_dwordx4 v5, s[28:31], s60 offen offset:1024 lds
  s_setprio 0
  s_waitcnt vmcnt(6)
  s_barrier
  s_add_u32 s62, s55, 3
  s_and_b32 s62, s62, 7
  s_lshl_b32 s62, s62, 7
  s_add_u32 m0, s59, 73728
  s_add_u32 s60, s56, s62
  s_add_u32 s61, s57, s62
  buffer_load_dwordx4 v2, s[24:27], s60 offen offset:0 lds
  buffer_load_dwordx4 v3, s[24:27], s60 offen offset:1024 lds
  buffer_load_dwordx4 v2, s[24:27], s61 offen offset:2048 lds
  buffer_load_dwordx4 v3, s[24:27], s61 offen offset:3072 lds
  s_add_u32 s62, s55, 3
  s_and_b32 s62, s62, 7
  s_mul_i32 s62, s62, 196608
  s_lshr_b32 s3, s59, 1
  s_add_u32 m0, s3, 90112
  s_add_u32 s60, s58, s62
  buffer_load_dwordx4 v4, s[28:31], s60 offen offset:0 lds
  buffer_load_dwordx4 v5, s[28:31], s60 offen offset:1024 lds
  s_waitcnt vmcnt(6)
  s_barrier
  s_add_u32 s62, s55, 4
  s_and_b32 s62, s62, 7
  s_lshl_b32 s62, s62, 7
  s_add_u32 m0, s59, 0
  s_add_u32 s60, s56, s62
  s_add_u32 s61, s57, s62
  buffer_load_dwordx4 v2, s[24:27], s60 offen offset:0 lds
  buffer_load_dwordx4 v3, s[24:27], s60 offen offset:1024 lds
  buffer_load_dwordx4 v2, s[24:27], s61 offen offset:2048 lds
  buffer_load_dwordx4 v3, s[24:27], s61 offen offset:3072 lds
  s_add_u32 s62, s55, 4
  s_and_b32 s62, s62, 7
  s_mul_i32 s62, s62, 196608
  s_lshr_b32 s3, s59, 1
  s_add_u32 m0, s3, 16384
  s_add_u32 s60, s58, s62
  buffer_load_dwordx4 v4, s[28:31], s60 offen offset:0 lds
  buffer_load_dwordx4 v5, s[28:31], s60 offen offset:1024 lds
  s_and_b32 s64, s52, 1
  s_lshr_b32 s41, s52, 1
  s_lshl_b32 s3, s54, 1
  s_add_u32 s40, s64, s3
  s_lshl_b32 s42, s40, 16
  s_lshl_b32 s3, s41, 15
  s_add_u32 s42, s42, s3
  v_lshlrev_b32 v244, 4, v0
  s_lshl_b32 s3, s41, 11
  s_lshl_b32 s65, s64, 12
  s_add_u32 s3, s3, s65
  s_add_u32 s66, s3, 151552
  s_xor_b32 s3, s3, 0x800
  s_add_u32 s67, s3, 151552
  v_add_u32 v248, s66, v244
  v_add_u32 v249, s67, v244
  v_and_b32 v242, 15, v0
  v_lshlrev_b32 v242, 4, v242
  v_lshrrev_b32 v243, 5, v0
  v_lshl_add_u32 v242, v243, 8, v242
  v_add_u32 v242, 2097152, v242
  s_lshl_b32 s3, s41, 12
  s_lshl_b32 s65, s64, 10
  s_add_u32 s3, s3, s65
  s_add_u32 s66, s3, 53248
  s_xor_b32 s3, s3, 0x1000
  s_add_u32 s67, s3, 53248
  v_add_u32 v254, s66, v244
  v_add_u32 v255, s67, v244
  s_lshl_b32 s3, s54, 1
  s_add_u32 s3, s3, s41
  s_lshl_b32 s3, s3, 12
  s_add_u32 s3, s3, 4194304
  s_sub_u32 s3, s3, s42
  v_mov_b32 v243, s3
  v_and_b32 v240, 31, v0
  v_cmp_gt_u32 s[64:65], 16, v240
  v_cmp_lt_u32 s[66:67], 16, v240
  v_mov_b32 v246, 0xdddddddd
  v_cndmask_b32 v245, v243, v242, s[64:65]
  v_cndmask_b32 v250, 0, 1, s[64:65]
  v_mov_b32 v243, 0x40000000
  v_cndmask_b32 v245, v245, v243, s[66:67]
  s_mov_b32 s46, 0
  s_and_b32 s48, s53, 0
  s_lshl_b32 s48, s48, 13
  s_add_u32 s49, s42, s48
  v_lshlrev_b32 v247, 7, v240
  s_lshl_b32 s3, s54, 1
  s_add_u32 s3, s3, s41
  s_lshl_b32 s3, s3, 12
  s_add_u32 s47, s3, 6291456
  s_waitcnt vmcnt(6)
  s_barrier
  s_add_u32 s62, s55, 5
  s_and_b32 s62, s62, 7
  s_lshl_b32 s62, s62, 7
  s_add_u32 m0, s59, 24576
  s_add_u32 s60, s56, s62
  s_add_u32 s61, s57, s62
  buffer_load_dwordx4 v2, s[24:27], s60 offen offset:0 lds
  buffer_load_dwordx4 v3, s[24:27], s60 offen offset:1024 lds
  buffer_load_dwordx4 v2, s[24:27], s61 offen offset:2048 lds
  buffer_load_dwordx4 v3, s[24:27], s61 offen offset:3072 lds
  s_add_u32 s62, s55, 5
  s_and_b32 s62, s62, 7
  s_mul_i32 s62, s62, 196608
  s_lshr_b32 s3, s59, 1
  s_add_u32 m0, s3, 40960
  s_add_u32 s60, s58, s62
  buffer_load_dwordx4 v4, s[28:31], s60 offen offset:0 lds
  buffer_load_dwordx4 v5, s[28:31], s60 offen offset:1024 lds
  v_mov_b32 v96, 0
  v_mov_b32 v97, 0
  v_mov_b32 v98, 0
  v_mov_b32 v99, 0
  v_mov_b32 v100, 0
  v_mov_b32 v101, 0
  v_mov_b32 v102, 0
  v_mov_b32 v103, 0
  v_mov_b32 v104, 0
  v_mov_b32 v105, 0
  v_mov_b32 v106, 0
  v_mov_b32 v107, 0
  v_mov_b32 v108, 0
  v_mov_b32 v109, 0
  v_mov_b32 v110, 0
  v_mov_b32 v111, 0
  v_mov_b32 v112, 0
  v_mov_b32 v113, 0
  v_mov_b32 v114, 0
  v_mov_b32 v115, 0
  v_mov_b32 v116, 0
  v_mov_b32 v117, 0
  v_mov_b32 v118, 0
  v_mov_b32 v119, 0
  v_mov_b32 v120, 0
  v_mov_b32 v121, 0
  v_mov_b32 v122, 0
  v_mov_b32 v123, 0
  v_mov_b32 v124, 0
  v_mov_b32 v125, 0
  v_mov_b32 v126, 0
  v_mov_b32 v127, 0
  v_mov_b32 v128, 0
  v_mov_b32 v129, 0
  v_mov_b32 v130, 0
  v_mov_b32 v131, 0
  v_mov_b32 v132, 0
  v_mov_b32 v133, 0
  v_mov_b32 v134, 0
  v_mov_b32 v135, 0
  v_mov_b32 v136, 0
  v_mov_b32 v137, 0
  v_mov_b32 v138, 0
  v_mov_b32 v139, 0
  v_mov_b32 v140, 0
  v_mov_b32 v141, 0
  v_mov_b32 v142, 0
  v_mov_b32 v143, 0
  v_mov_b32 v144, 0
  v_mov_b32 v145, 0
  v_mov_b32 v146, 0
  v_mov_b32 v147, 0
  v_mov_b32 v148, 0
  v_mov_b32 v149, 0
  v_mov_b32 v150, 0
  v_mov_b32 v151, 0
  v_mov_b32 v152, 0
  v_mov_b32 v153, 0
  v_mov_b32 v154, 0
  v_mov_b32 v155, 0
  v_mov_b32 v156, 0
  v_mov_b32 v157, 0
  v_mov_b32 v158, 0
  v_mov_b32 v159, 0
  v_mov_b32 v184, 0
  v_mov_b32 v185, 0
  v_mov_b32 v186, 0
  v_mov_b32 v187, 0
  v_mov_b32 v188, 0
  v_mov_b32 v189, 0
  v_mov_b32 v190, 0
  v_mov_b32 v191, 0
  v_mov_b32 v236, 0
  v_mov_b32 v237, 0
  v_mov_b32 v238, 0
  v_mov_b32 v239, 0
  s_waitcnt vmcnt(6)
  s_barrier
  s_add_u32 s62, s55, 6
  s_and_b32 s62, s62, 7
  s_lshl_b32 s62, s62, 7
  s_add_u32 m0, s59, 49152
  s_add_u32 s60, s56, s62
  s_add_u32 s61, s57, s62
  buffer_load_dwordx4 v2, s[24:27], s60 offen offset:0 lds
  buffer_load_dwordx4 v3, s[24:27], s60 offen offset:1024 lds
  buffer_load_dwordx4 v2, s[24:27], s61 offen offset:2048 lds
  buffer_load_dwordx4 v3, s[24:27], s61 offen offset:3072 lds
  s_add_u32 s62, s55, 6
  s_and_b32 s62, s62, 7
  s_mul_i32 s62, s62, 196608
  s_lshr_b32 s3, s59, 1
  s_add_u32 m0, s3, 65536
  s_add_u32 s60, s58, s62
  buffer_load_dwordx4 v4, s[28:31], s60 offen offset:0 lds
  buffer_load_dwordx4 v5, s[28:31], s60 offen offset:1024 lds
  s_waitcnt vmcnt(6)
  s_barrier
  s_add_u32 s62, s55, 7
  s_and_b32 s62, s62, 7
  s_lshl_b32 s62, s62, 7
  s_add_u32 m0, s59, 73728
  s_add_u32 s60, s56, s62
  s_add_u32 s61, s57, s62
  buffer_load_dwordx4 v2, s[24:27], s60 offen offset:0 lds
  buffer_load_dwordx4 v3, s[24:27], s60 offen offset:1024 lds
  buffer_load_dwordx4 v2, s[24:27], s61 offen offset:2048 lds
  buffer_load_dwordx4 v3, s[24:27], s61 offen offset:3072 lds
  s_add_u32 s62, s55, 7
  s_and_b32 s62, s62, 7
  s_mul_i32 s62, s62, 196608
  s_lshr_b32 s3, s59, 1
  s_add_u32 m0, s3, 90112
  s_add_u32 s60, s58, s62
  buffer_load_dwordx4 v4, s[28:31], s60 offen offset:0 lds
  buffer_load_dwordx4 v5, s[28:31], s60 offen offset:1024 lds
  v_mov_b32 v12, 0
  buffer_load_dwordx2 v[14:15], v12, s[72:75], 0 offen sc1
  s_waitcnt vmcnt(7)
  s_barrier
  s_add_u32 s62, s55, 0
  s_and_b32 s62, s62, 7
  s_mul_i32 s62, s62, 196608
  s_lshr_b32 s3, s59, 2
  s_add_u32 m0, s3, 98304
  s_add_u32 s60, s68, s62
  buffer_load_dwordx4 v6, s[28:31], s60 offen lds
  s_add_u32 s62, s55, 1
  s_and_b32 s62, s62, 7
  s_mul_i32 s62, s62, 196608
  s_lshr_b32 s3, s59, 2
  s_add_u32 m0, s3, 102400
  s_add_u32 s60, s68, s62
  buffer_load_dwordx4 v6, s[28:31], s60 offen lds
  s_add_u32 s62, s55, 2
  s_and_b32 s62, s62, 7
  s_mul_i32 s62, s62, 196608
  s_lshr_b32 s3, s59, 2
  s_add_u32 m0, s3, 106496
  s_add_u32 s60, s68, s62
  buffer_load_dwordx4 v6, s[28:31], s60 offen lds
  s_add_u32 s62, s55, 3
  s_and_b32 s62, s62, 7
  s_mul_i32 s62, s62, 196608
  s_lshr_b32 s3, s59, 2
  s_add_u32 m0, s3, 110592
  s_add_u32 s60, s68, s62
  buffer_load_dwordx4 v6, s[28:31], s60 offen lds
  s_add_u32 s62, s55, 4
  s_and_b32 s62, s62, 7
  s_mul_i32 s62, s62, 196608
  s_lshr_b32 s3, s59, 2
  s_add_u32 m0, s3, 114688
  s_add_u32 s60, s68, s62
  buffer_load_dwordx4 v6, s[28:31], s60 offen lds
  s_add_u32 s62, s55, 5
  s_and_b32 s62, s62, 7
  s_mul_i32 s62, s62, 196608
  s_lshr_b32 s3, s59, 2
  s_add_u32 m0, s3, 118784
  s_add_u32 s60, s68, s62
  buffer_load_dwordx4 v6, s[28:31], s60 offen lds
  s_add_u32 s62, s55, 6
  s_and_b32 s62, s62, 7
  s_mul_i32 s62, s62, 196608
  s_lshr_b32 s3, s59, 2
  s_add_u32 m0, s3, 122880
  s_add_u32 s60, s68, s62
  buffer_load_dwordx4 v6, s[28:31], s60 offen lds
  s_add_u32 s62, s55, 7
  s_and_b32 s62, s62, 7
  s_mul_i32 s62, s62, 196608
  s_lshr_b32 s3, s59, 2
  s_add_u32 m0, s3, 126976
  s_add_u32 s60, s68, s62
  buffer_load_dwordx4 v6, s[28:31], s60 offen lds
  s_waitcnt vmcnt(9)
  s_barrier
  s_bitcmp0_b32 s52, 0
  s_cselect_b32 s32, s12, s14
  s_cselect_b32 s33, s13, s15
  s_mov_b32 s34, 1835008
  s_mov_b32 s35, 0x20000
  v_lshrrev_b32 v50, 3, v0
  v_mul_u32_u24 v50, 3584, v50
  v_bfe_u32 v51, v0, 4, 1
  v_lshlrev_b32 v51, 1, v51
  s_and_b32 s3, s52, 1
  s_lshl_b32 s61, s3, 13
  s_lshl_b32 s3, s3, 2
  v_xor_b32 v51, s3, v51
  v_and_b32 v52, 7, v0
  v_xor_b32 v51, v51, v52
  v_lshl_add_u32 v50, v51, 4, v50
  s_lshr_b32 s3, s52, 1
  s_lshl_b32 s60, s3, 12
  s_add_u32 s60, s60, s61
  s_add_u32 m0, s60, 131072
  s_and_b32 s62, s55, 7
  s_lshl_b32 s62, s62, 1
  s_add_u32 s3, s3, s62
  s_mul_i32 s3, s3, 114688
  s_lshl_b32 s60, s54, 7
  s_add_u32 s60, s60, s3
  buffer_load_dwordx4 v50, s[32:35], s60 offen offset:0 lds
  s_add_u32 s60, s60, 27648
  buffer_load_dwordx4 v50, s[32:35], s60 offen offset:1024 lds
  s_add_u32 s60, s60, 27648
  buffer_load_dwordx4 v50, s[32:35], s60 offen offset:2048 lds
  s_add_u32 s60, s60, 27648
  buffer_load_dwordx4 v50, s[32:35], s60 offen offset:3072 lds
  s_waitcnt vmcnt(0)
  v_cmp_ne_u64 vcc, 0, v[14:15]
  s_nop 0
  s_cmp_eq_u64 vcc, -1
  s_cbranch_scc1 tag1
  v_mov_b32 v12, 0
poll2:
  buffer_load_dwordx2 v[14:15], v12, s[72:75], 0 offen sc1
  s_waitcnt vmcnt(0)
  v_cmp_ne_u64 vcc, 0, v[14:15]
  s_cmp_eq_u32 s70, 0
  s_cbranch_scc1 poll2_out
  s_sub_u32 s70, s70, 1
  s_cmp_eq_u64 vcc, -1
  s_cbranch_scc0 poll2
poll2_out:
tag1:
  s_lshl_b32 s3, s52, 8
  s_add_u32 s3, s3, 161280
  v_lshl_add_u32 v11, v0, 2, s3
  v_mov_b32 v17, 1
  ds_write_b32 v11, v17
  s_setprio 3
  s_mov_b64 exec, 0
  s_cmp_eq_u32 s52, 0
  s_cbranch_scc1 PADa_0
  s_cmp_eq_u32 s52, 1
  s_cbranch_scc1 PADa_1
  s_cmp_eq_u32 s52, 2
  s_cbranch_scc1 PADa_2
  s_branch PADa_3
RETa:
  s_mov_b64 exec, -1
  v_and_b32 v16, 3, v0
  v_lshlrev_b32 v16, 8, v16
  v_add_u32 v12, 160256, v16
  ds_read_b32 v13, v12
  s_waitcnt lgkmcnt(0)
  v_cmp_le_u32 vcc, 2, v13
  s_nop 0
  s_cmp_eq_u64 vcc, -1
  s_cbranch_scc0 sig3_slow
sig3_ok:
  ds_read_b128 v[160:163], v254 offset:0
  ds_read_b128 v[164:167], v254 offset:2048
  ds_read_b128 v[168:171], v255 offset:0
  ds_read_b128 v[172:175], v255 offset:2048
poll4:
  buffer_load_dwordx2 v[242:243], v247, s[36:39], s47 offen sc1
  s_waitcnt vmcnt(0)
  v_cmp_eq_u64 vcc, v[242:243], v[14:15]
  s_cmp_eq_u32 s70, 0
  s_cbranch_scc1 poll4_out
  s_sub_u32 s70, s70, 1
  s_cmp_eq_u64 vcc, -1
  s_cbranch_scc0 poll4
poll4_out:
  v_mad_u32_u24 v251, v250, s48, v245
  buffer_load_dwordx4 v[192:195], v244, s[36:39], s49 offen offset:0 sc1
  buffer_load_dwordx4 v[208:211], v251, s[36:39], s42 offen offset:0 sc1
  buffer_load_dwordx4 v[224:227], v251, s[36:39], s42 offen offset:512 sc1
  buffer_load_dwordx4 v[196:199], v244, s[36:39], s49 offen offset:1024 sc1
  buffer_load_dwordx4 v[212:215], v251, s[36:39], s42 offen offset:1024 sc1
  buffer_load_dwordx4 v[228:231], v251, s[36:39], s42 offen offset:1536 sc1
  buffer_load_dwordx4 v[200:203], v244, s[36:39], s49 offen offset:2048 sc1
  buffer_load_dwordx4 v[216:219], v251, s[36:39], s42 offen offset:2048 sc1
  buffer_load_dwordx4 v[232:235], v251, s[36:39], s42 offen offset:2560 sc1
  v_mov_b32 v17, 2
  s_waitcnt lgkmcnt(0)
  ds_write_b32 v11, v17
  ds_read_b32 v13, v12
  s_waitcnt lgkmcnt(0)
  v_cmp_le_u32 vcc, 3, v13
  s_nop 0
  s_cmp_eq_u64 vcc, -1
  s_cbranch_scc0 sig5_slow
sig5_ok:
  ds_read_b128 v[16:19], v248 offset:0
  ds_read_b128 v[20:23], v248 offset:1024
  ds_read_b128 v[24:27], v249 offset:0
  ds_read_b128 v[28:31], v249 offset:1024
  s_waitcnt lgkmcnt(0)
  v_mfma_f32_32x32x16_bf16 v[32:47], v[160:163], v[16:19], 0
  v_mfma_f32_32x32x16_bf16 v[48:63], v[164:167], v[20:23], 0
  v_mfma_f32_32x32x16_bf16 v[64:79], v[168:171], v[24:27], 0
  v_mfma_f32_32x32x16_bf16 v[80:95], v[172:175], v[28:31], 0
  s_nop 8
  v_max3_f32 v32, v32, v36, v40
  v_max3_f32 v32, v32, v44, v47
  s_nop 0
  v_max3_f32 v48, v48, v52, v56
  v_max3_f32 v48, v48, v60, v63
  v_max3_f32 v64, v64, v68, v72
  v_max3_f32 v64, v64, v76, v79
  v_max3_f32 v80, v80, v84, v88
  v_max3_f32 v80, v80, v92, v95
  v_mov_b32 v33, v32
  v_mov_b32 v49, v48
  v_mov_b32 v65, v64
  v_mov_b32 v81, v80
  s_nop 0
  v_permlane32_swap_b32 v32, v33
  v_permlane32_swap_b32 v48, v49
  v_permlane32_swap_b32 v64, v65
  v_permlane32_swap_b32 v80, v81
  v_max_f32 v32, v32, v33
  v_max_f32 v48, v48, v49
  v_max_f32 v64, v64, v65
  v_max_f32 v80, v80, v81
  v_sub_f32 v32, 0, v32
  v_mov_b32 v33, v32
  v_pk_mov_b32 v[34:35], v[32:33], v[32:33] op_sel:[0,0]
  v_pk_mov_b32 v[36:37], v[32:33], v[32:33] op_sel:[0,0]
  v_pk_mov_b32 v[38:39], v[32:33], v[32:33] op_sel:[0,0]
  v_pk_mov_b32 v[40:41], v[32:33], v[32:33] op_sel:[0,0]
  v_pk_mov_b32 v[42:43], v[32:33], v[32:33] op_sel:[0,0]
  v_pk_mov_b32 v[44:45], v[32:33], v[32:33] op_sel:[0,0]
  v_pk_mov_b32 v[46:47], v[32:33], v[32:33] op_sel:[0,0]
  v_sub_f32 v48, 0, v48
  v_mov_b32 v49, v48
  v_pk_mov_b32 v[50:51], v[48:49], v[48:49] op_sel:[0,0]
  v_pk_mov_b32 v[52:53], v[48:49], v[48:49] op_sel:[0,0]
  v_pk_mov_b32 v[54:55], v[48:49], v[48:49] op_sel:[0,0]
  v_pk_mov_b32 v[56:57], v[48:49], v[48:49] op_sel:[0,0]
  v_pk_mov_b32 v[58:59], v[48:49], v[48:49] op_sel:[0,0]
  v_pk_mov_b32 v[60:61], v[48:49], v[48:49] op_sel:[0,0]
  v_pk_mov_b32 v[62:63], v[48:49], v[48:49] op_sel:[0,0]
  v_sub_f32 v64, 0, v64
  v_mov_b32 v65, v64
  v_pk_mov_b32 v[66:67], v[64:65], v[64:65] op_sel:[0,0]
  v_pk_mov_b32 v[68:69], v[64:65], v[64:65] op_sel:[0,0]
  v_pk_mov_b32 v[70:71], v[64:65], v[64:65] op_sel:[0,0]
  v_pk_mov_b32 v[72:73], v[64:65], v[64:65] op_sel:[0,0]
  v_pk_mov_b32 v[74:75], v[64:65], v[64:65] op_sel:[0,0]
  v_pk_mov_b32 v[76:77], v[64:65], v[64:65] op_sel:[0,0]
  v_pk_mov_b32 v[78:79], v[64:65], v[64:65] op_sel:[0,0]
  v_sub_f32 v80, 0, v80
  v_mov_b32 v81, v80
  v_pk_mov_b32 v[82:83], v[80:81], v[80:81] op_sel:[0,0]
  v_pk_mov_b32 v[84:85], v[80:81], v[80:81] op_sel:[0,0]
  v_pk_mov_b32 v[86:87], v[80:81], v[80:81] op_sel:[0,0]
  v_pk_mov_b32 v[88:89], v[80:81], v[80:81] op_sel:[0,0]
  v_pk_mov_b32 v[90:91], v[80:81], v[80:81] op_sel:[0,0]
  v_pk_mov_b32 v[92:93], v[80:81], v[80:81] op_sel:[0,0]
  v_pk_mov_b32 v[94:95], v[80:81], v[80:81] op_sel:[0,0]
LA_restart:
  s_mov_b32 s28, s22
  s_mov_b32 s29, s23
  s_mov_b32 s30, 18874368
  s_mov_b32 s31, 0x20000
  s_add_u32 s44, s49, 4096
  s_add_u32 s50, s48, 4096
  v_mad_u32_u24 v252, v250, s50, v245
  s_mov_b32 s45, 0
  s_mov_b32 s43, s49
  s_waitcnt vmcnt(8)
  v_mfma_f32_32x32x16_bf16 v[160:175], v[192:195], v[16:19], v[32:47]
  s_waitcnt vmcnt(6)
  s_setprio 1
  s_nop 9
.p2align 6
LA_loop:
  v_exp_f32 v160, v160
  v_exp_f32 v161, v161
  v_smfmac_f32_32x32x32_bf16 v[144:159], v[236:239], v[184:191], v246
  buffer_load_dwordx4 v[236:239], v251, s[36:39], s42 offen offset:3584 sc1
  buffer_load_dwordx4 v[220:223], v251, s[36:39], s42 offen offset:3072 sc1
  v_exp_f32 v162, v162
  v_exp_f32 v163, v163
  v_exp_f32 v164, v164
  v_exp_f32 v165, v165
  v_mfma_f32_32x32x16_bf16 v[176:191], v[192:195], v[20:23], v[48:63]
  v_exp_f32 v166, v166
  v_exp_f32 v167, v167
  v_exp_f32 v168, v168
  v_exp_f32 v169, v169
  v_exp_f32 v170, v170
  v_exp_f32 v171, v171
  v_smfmac_f32_32x32x32_bf16 v[96:111], v[208:211], v[160:167], v246
  v_exp_f32 v172, v172
  v_exp_f32 v173, v173
  v_exp_f32 v174, v174
  v_exp_f32 v175, v175
  v_exp_f32 v176, v176
  v_exp_f32 v177, v177
  v_smfmac_f32_32x32x32_bf16 v[96:111], v[224:227], v[168:175], v246
  v_exp_f32 v178, v178
  v_exp_f32 v179, v179
  v_exp_f32 v180, v180
  v_exp_f32 v181, v181
  v_mfma_f32_32x32x16_bf16 v[160:175], v[192:195], v[24:27], v[64:79]
  v_exp_f32 v182, v182
  v_exp_f32 v183, v183
  v_exp_f32 v184, v184
  v_exp_f32 v185, v185
  v_exp_f32 v186, v186
  v_exp_f32 v187, v187
  v_smfmac_f32_32x32x32_bf16 v[112:127], v[208:211], v[176:183], v246
  v_exp_f32 v188, v188
  v_exp_f32 v189, v189
  v_exp_f32 v190, v190
  v_exp_f32 v191, v191
  v_exp_f32 v160, v160
  v_exp_f32 v161, v161
  v_smfmac_f32_32x32x32_bf16 v[112:127], v[224:227], v[184:191], v246
  buffer_load_dwordx4 v[204:207], v244, s[36:39], s43 offen offset:3072 sc1
  v_exp_f32 v162, v162
  v_exp_f32 v163, v163
  v_exp_f32 v164, v164
  v_exp_f32 v165, v165
  v_mfma_f32_32x32x16_bf16 v[176:191], v[192:195], v[28:31], v[80:95]
  v_exp_f32 v166, v166
  v_exp_f32 v167, v167
  v_exp_f32 v168, v168
  v_exp_f32 v169, v169
  v_exp_f32 v170, v170
  v_exp_f32 v171, v171
  v_smfmac_f32_32x32x32_bf16 v[128:143], v[208:211], v[160:167], v246
  v_exp_f32 v172, v172
  v_exp_f32 v173, v173
  v_exp_f32 v174, v174
  v_exp_f32 v175, v175
  v_exp_f32 v176, v176
  v_exp_f32 v177, v177
  v_smfmac_f32_32x32x32_bf16 v[128:143], v[224:227], v[168:175], v246
  v_exp_f32 v178, v178
  v_exp_f32 v179, v179
  v_exp_f32 v180, v180
  v_exp_f32 v181, v181
  s_waitcnt vmcnt(6)
  v_mfma_f32_32x32x16_bf16 v[160:175], v[196:199], v[16:19], v[32:47]
  v_exp_f32 v182, v182
  v_exp_f32 v183, v183
  v_exp_f32 v184, v184
  v_exp_f32 v185, v185
  v_exp_f32 v186, v186
  v_exp_f32 v187, v187
  v_smfmac_f32_32x32x32_bf16 v[144:159], v[208:211], v[176:183], v246
  v_exp_f32 v188, v188
  v_exp_f32 v189, v189
  v_exp_f32 v190, v190
  v_exp_f32 v191, v191
  v_exp_f32 v160, v160
  v_exp_f32 v161, v161
  v_smfmac_f32_32x32x32_bf16 v[144:159], v[224:227], v[184:191], v246
  buffer_load_dwordx4 v[224:227], v252, s[28:31], s42 offen offset:512 sc1
  buffer_load_dwordx4 v[208:211], v252, s[28:31], s42 offen offset:0 sc1
  v_exp_f32 v162, v162
  v_exp_f32 v163, v163
  v_exp_f32 v164, v164
  v_exp_f32 v165, v165
  v_mfma_f32_32x32x16_bf16 v[176:191], v[196:199], v[20:23], v[48:63]
  v_exp_f32 v166, v166
  v_exp_f32 v167, v167
  v_exp_f32 v168, v168
  v_exp_f32 v169, v169
  v_exp_f32 v170, v170
  v_exp_f32 v171, v171
  v_smfmac_f32_32x32x32_bf16 v[96:111], v[212:215], v[160:167], v246
  v_exp_f32 v172, v172
  v_exp_f32 v173, v173
  v_exp_f32 v174, v174
  v_exp_f32 v175, v175
  v_exp_f32 v176, v176
  v_exp_f32 v177, v177
  v_smfmac_f32_32x32x32_bf16 v[96:111], v[228:231], v[168:175], v246
  v_exp_f32 v178, v178
  v_exp_f32 v179, v179
  v_exp_f32 v180, v180
  v_exp_f32 v181, v181
  v_mfma_f32_32x32x16_bf16 v[160:175], v[196:199], v[24:27], v[64:79]
  v_exp_f32 v182, v182
  v_exp_f32 v183, v183
  v_exp_f32 v184, v184
  v_exp_f32 v185, v185
  v_exp_f32 v186, v186
  v_exp_f32 v187, v187
  v_smfmac_f32_32x32x32_bf16 v[112:127], v[212:215], v[176:183], v246
  v_exp_f32 v188, v188
  v_exp_f32 v189, v189
  v_exp_f32 v190, v190
  v_exp_f32 v191, v191
  v_exp_f32 v160, v160
  v_exp_f32 v161, v161
  v_smfmac_f32_32x32x32_bf16 v[112:127], v[228:231], v[184:191], v246
  buffer_load_dwordx4 v[192:195], v244, s[28:31], s44 offen offset:0 sc1
  v_exp_f32 v162, v162
  v_exp_f32 v163, v163
  v_exp_f32 v164, v164
  v_exp_f32 v165, v165
  v_mfma_f32_32x32x16_bf16 v[176:191], v[196:199], v[28:31], v[80:95]
  v_exp_f32 v166, v166
  v_exp_f32 v167, v167
  v_exp_f32 v168, v168
  v_exp_f32 v169, v169
  v_exp_f32 v170, v170
  v_exp_f32 v171, v171
  v_smfmac_f32_32x32x32_bf16 v[128:143], v[212:215], v[160:167], v246
  v_exp_f32 v172, v172
  v_exp_f32 v173, v173
  v_exp_f32 v174, v174
  v_exp_f32 v175, v175
  v_exp_f32 v176, v176
  v_exp_f32 v177, v177
  v_smfmac_f32_32x32x32_bf16 v[128:143], v[228:231], v[168:175], v246
  v_exp_f32 v178, v178
  v_exp_f32 v179, v179
  v_exp_f32 v180, v180
  v_exp_f32 v181, v181
  s_waitcnt vmcnt(6)
  v_mfma_f32_32x32x16_bf16 v[160:175], v[200:203], v[16:19], v[32:47]
  v_exp_f32 v182, v182
  v_exp_f32 v183, v183
  v_exp_f32 v184, v184
  v_exp_f32 v185, v185
  v_exp_f32 v186, v186
  v_exp_f32 v187, v187
  v_smfmac_f32_32x32x32_bf16 v[144:159], v[212:215], v[176:183], v246
  v_exp_f32 v188, v188
  v_exp_f32 v189, v189
  v_exp_f32 v190, v190
  v_exp_f32 v191, v191
  v_exp_f32 v160, v160
  v_exp_f32 v161, v161
  v_smfmac_f32_32x32x32_bf16 v[144:159], v[228:231], v[184:191], v246
  buffer_load_dwordx4 v[228:231], v252, s[28:31], s42 offen offset:1536 sc1
  buffer_load_dwordx4 v[212:215], v252, s[28:31], s42 offen offset:1024 sc1
  v_exp_f32 v162, v162
  v_exp_f32 v163, v163
  v_exp_f32 v164, v164
  v_exp_f32 v165, v165
  v_mfma_f32_32x32x16_bf16 v[176:191], v[200:203], v[20:23], v[48:63]
  v_exp_f32 v166, v166
  v_exp_f32 v167, v167
  v_exp_f32 v168, v168
  v_exp_f32 v169, v169
  v_exp_f32 v170, v170
  v_exp_f32 v171, v171
  v_smfmac_f32_32x32x32_bf16 v[96:111], v[216:219], v[160:167], v246
  v_exp_f32 v172, v172
  v_exp_f32 v173, v173
  v_exp_f32 v174, v174
  v_exp_f32 v175, v175
  v_exp_f32 v176, v176
  v_exp_f32 v177, v177
  v_smfmac_f32_32x32x32_bf16 v[96:111], v[232:235], v[168:175], v246
  v_exp_f32 v178, v178
  v_exp_f32 v179, v179
  v_exp_f32 v180, v180
  v_exp_f32 v181, v181
  v_mfma_f32_32x32x16_bf16 v[160:175], v[200:203], v[24:27], v[64:79]
  v_exp_f32 v182, v182
  v_exp_f32 v183, v183
  v_exp_f32 v184, v184
  v_exp_f32 v185, v185
  v_exp_f32 v186, v186
  v_exp_f32 v187, v187
  v_smfmac_f32_32x32x32_bf16 v[112:127], v[216:219], v[176:183], v246
  v_exp_f32 v188, v188
  v_exp_f32 v189, v189
  v_exp_f32 v190, v190
  v_exp_f32 v191, v191
  v_exp_f32 v160, v160
  v_exp_f32 v161, v161
  v_smfmac_f32_32x32x32_bf16 v[112:127], v[232:235], v[184:191], v246
  buffer_load_dwordx4 v[196:199], v244, s[28:31], s44 offen offset:1024 sc1
  v_exp_f32 v162, v162
  v_exp_f32 v163, v163
  v_exp_f32 v164, v164
  v_exp_f32 v165, v165
  v_mfma_f32_32x32x16_bf16 v[176:191], v[200:203], v[28:31], v[80:95]
  v_exp_f32 v166, v166
  v_exp_f32 v167, v167
  v_exp_f32 v168, v168
  v_exp_f32 v169, v169
  v_exp_f32 v170, v170
  v_exp_f32 v171, v171
  v_smfmac_f32_32x32x32_bf16 v[128:143], v[216:219], v[160:167], v246
  v_exp_f32 v172, v172
  v_exp_f32 v173, v173
  v_exp_f32 v174, v174
  v_exp_f32 v175, v175
  v_exp_f32 v176, v176
  v_exp_f32 v177, v177
  v_smfmac_f32_32x32x32_bf16 v[128:143], v[232:235], v[168:175], v246
  v_exp_f32 v178, v178
  v_exp_f32 v179, v179
  v_exp_f32 v180, v180
  v_exp_f32 v181, v181
  s_waitcnt vmcnt(6)
  v_mfma_f32_32x32x16_bf16 v[160:175], v[204:207], v[16:19], v[32:47]
  v_exp_f32 v182, v182
  v_exp_f32 v183, v183
  v_exp_f32 v184, v184
  v_exp_f32 v185, v185
  v_exp_f32 v186, v186
  v_exp_f32 v187, v187
  v_smfmac_f32_32x32x32_bf16 v[144:159], v[216:219], v[176:183], v246
  v_exp_f32 v188, v188
  v_exp_f32 v189, v189
  v_exp_f32 v190, v190
  v_exp_f32 v191, v191
  v_exp_f32 v160, v160
  v_exp_f32 v161, v161
  v_smfmac_f32_32x32x32_bf16 v[144:159], v[232:235], v[184:191], v246
  buffer_load_dwordx4 v[232:235], v252, s[28:31], s42 offen offset:2560 sc1
  buffer_load_dwordx4 v[216:219], v252, s[28:31], s42 offen offset:2048 sc1
  v_exp_f32 v162, v162
  v_exp_f32 v163, v163
  v_exp_f32 v164, v164
  v_exp_f32 v165, v165
  v_mfma_f32_32x32x16_bf16 v[176:191], v[204:207], v[20:23], v[48:63]
  v_exp_f32 v166, v166
  v_exp_f32 v167, v167
  v_exp_f32 v168, v168
  v_exp_f32 v169, v169
  v_exp_f32 v170, v170
  v_exp_f32 v171, v171
  v_smfmac_f32_32x32x32_bf16 v[96:111], v[220:223], v[160:167], v246
  v_exp_f32 v172, v172
  v_exp_f32 v173, v173
  v_exp_f32 v174, v174
  v_exp_f32 v175, v175
  v_exp_f32 v176, v176
  v_exp_f32 v177, v177
  v_smfmac_f32_32x32x32_bf16 v[96:111], v[236:239], v[168:175], v246
  v_exp_f32 v178, v178
  v_exp_f32 v179, v179
  v_exp_f32 v180, v180
  v_exp_f32 v181, v181
  v_mfma_f32_32x32x16_bf16 v[160:175], v[204:207], v[24:27], v[64:79]
  v_exp_f32 v182, v182
  v_exp_f32 v183, v183
  v_exp_f32 v184, v184
  v_exp_f32 v185, v185
  v_exp_f32 v186, v186
  v_exp_f32 v187, v187
  v_smfmac_f32_32x32x32_bf16 v[112:127], v[220:223], v[176:183], v246
  v_exp_f32 v188, v188
  v_exp_f32 v189, v189
  v_exp_f32 v190, v190
  v_exp_f32 v191, v191
  v_exp_f32 v160, v160
  v_exp_f32 v161, v161
  v_smfmac_f32_32x32x32_bf16 v[112:127], v[236:239], v[184:191], v246
  buffer_load_dwordx4 v[200:203], v244, s[28:31], s44 offen offset:2048 sc1
  v_exp_f32 v162, v162
  v_exp_f32 v163, v163
  v_exp_f32 v164, v164
  v_exp_f32 v165, v165
  v_mfma_f32_32x32x16_bf16 v[176:191], v[204:207], v[28:31], v[80:95]
  v_exp_f32 v166, v166
  v_exp_f32 v167, v167
  v_exp_f32 v168, v168
  v_exp_f32 v169, v169
  v_exp_f32 v170, v170
  v_exp_f32 v171, v171
  v_smfmac_f32_32x32x32_bf16 v[128:143], v[220:223], v[160:167], v246
  v_exp_f32 v172, v172
  v_exp_f32 v173, v173
  v_exp_f32 v174, v174
  v_exp_f32 v175, v175
  v_exp_f32 v176, v176
  v_exp_f32 v177, v177
  v_smfmac_f32_32x32x32_bf16 v[128:143], v[236:239], v[168:175], v246
  v_exp_f32 v178, v178
  v_exp_f32 v179, v179
  v_exp_f32 v180, v180
  v_exp_f32 v181, v181
  s_waitcnt vmcnt(6)
  v_mfma_f32_32x32x16_bf16 v[160:175], v[192:195], v[16:19], v[32:47]
  v_exp_f32 v182, v182
  v_exp_f32 v183, v183
  v_exp_f32 v184, v184
  v_exp_f32 v185, v185
  v_exp_f32 v186, v186
  v_exp_f32 v187, v187
  v_smfmac_f32_32x32x32_bf16 v[144:159], v[220:223], v[176:183], v246
  s_add_u32 s50, s50, 4096
  v_mov_b32 v251, v252
  s_mov_b32 s43, s44
  s_add_u32 s44, s44, 4096
  v_mad_u32_u24 v252, v250, s50, v245
  s_cmp_lt_u32 s50, 0x8000
  s_cselect_b32 s30, s38, 0
  s_cmp_le_u32 s50, 0x8000
  v_exp_f32 v188, v188
  v_exp_f32 v189, v189
  v_exp_f32 v190, v190
  v_exp_f32 v191, v191
  s_cbranch_scc1 LA_loop
PADa_40:
  s_cbranch_execz RETa
  s_setprio 3
  v_smfmac_f32_32x32x32_bf16 v[144:159], v[236:239], v[184:191], v246
  ds_read_b32 v13, v12
  s_mov_b32 s64, 0x2b800000
  s_mov_b32 s65, 0x53800000
  s_mov_b32 s66, 0x7f800000
  s_mul_i32 s3, s52, 5120
  s_add_u32 s3, s3, 131072
  s_xor_b32 s67, s52, 2
  s_mul_i32 s71, s67, 5120
  s_add_u32 s71, s71, 131072
  v_add_u32 v4, s3, v244
  v_lshlrev_b32 v6, 3, v0
  v_add_u32 v7, s71, v6
  v_add_u32 v6, s3, v6
  v_mov_b32 v105, v104
  v_mov_b32 v121, v120
  v_mov_b32 v137, v136
  v_maximum3_f32 v240, |v96|, |v97|, |v98|
  v_permlane32_swap_b32 v104, v105
  v_permlane32_swap_b32 v120, v121
  v_permlane32_swap_b32 v136, v137
  s_waitcnt lgkmcnt(0)
  v_cmp_le_u32 vcc, 6, v13
  s_nop 0
  s_cmp_eq_u64 vcc, -1
  s_cbranch_scc0 sig6_slow
sig6_ok:
  ds_write_b128 v4, v[128:131] offset:0
  ds_write_b128 v4, v[132:135] offset:1024
  v_maximum3_f32 v240, v240, |v99|, |v100|
  v_maximum3_f32 v240, v240, |v101|, |v102|
  v_maximum3_f32 v240, v240, |v103|, |v112|
  v_maximum3_f32 v240, v240, |v113|, |v114|
  v_maximum3_f32 v240, v240, |v115|, |v116|
  v_maximum3_f32 v240, v240, |v117|, |v118|
  v_maximum3_f32 v240, v240, |v119|, |v128|
  v_maximum3_f32 v240, v240, |v129|, |v130|
  v_maximum3_f32 v240, v240, |v131|, |v132|
  v_maximum3_f32 v240, v240, |v133|, |v134|
  v_mov_b32 v153, v152
  v_maximum3_f32 v240, v240, |v135|, |v144|
  v_maximum3_f32 v240, v240, |v145|, |v146|
  v_permlane32_swap_b32 v152, v153
  v_maximum3_f32 v240, v240, |v147|, |v148|
  v_maximum3_f32 v240, v240, |v149|, |v150|
  ds_write_b128 v4, v[144:147] offset:2560
  ds_write_b128 v4, v[148:151] offset:3584
  v_minimum3_f32 v241, v104, v120, v136
  v_maximum3_f32 v242, v104, v120, v136
  v_maximum3_f32 v240, v240, |v151|, |v151|
  v_minimum3_f32 v241, v241, v152, v152
  v_maximum3_f32 v242, v242, v152, v152
  v_cmp_gt_f32 vcc, s66, v240
  v_cmp_le_f32 s[94:95], s64, v241
  v_cmp_ge_f32 s[68:69], s65, v242
  s_and_b64 vcc, vcc, s[94:95]
  s_and_b64 vcc, vcc, s[68:69]
  s_cmp_eq_u64 vcc, -1
  s_cbranch_scc0 LA_unsafe
LA_merge:
  v_mov_b32 v137, v64
  v_mov_b32 v153, v80
  ds_write_b64 v6, v[136:137] offset:2048
  ds_write_b64 v6, v[152:153] offset:4608
  v_add_u32 v5, s71, v244
  s_lshl_b32 s3, s52, 8
  s_add_u32 s3, s3, 161280
  v_lshl_add_u32 v8, v0, 2, s3
  s_lshl_b32 s3, s67, 8
  s_add_u32 s3, s3, 161280
  v_lshl_add_u32 v9, v0, 2, s3
PADa_41:
  s_cbranch_execz RETa
  v_mov_b32 v10, 3
  s_waitcnt lgkmcnt(0)
  ds_write_b32 v8, v10
  ds_read_b32 v11, v9
  s_lshl_b32 s3, s53, 2
  s_lshl_b32 s64, s41, 1
  s_add_u32 s3, s3, s64
  s_lshl_b32 s66, s3, 5
  s_add_u32 s66, s66, s40
  s_lshl_b32 s64, s66, 10
  s_add_u32 s64, s64, 8388608
  s_add_u32 s65, s64, 32768
  s_lshl_b32 s66, s66, 7
  s_add_u32 s66, s66, 6684672
  v_lshlrev_b32 v13, 12, v0
  s_waitcnt lgkmcnt(0)
  v_cmp_le_u32 vcc, 3, v11
  s_nop 0
  s_cmp_eq_u64 vcc, -1
  s_cbranch_scc0 sig7_slow
sig7_ok:
  ds_read_b64 v[136:137], v7 offset:2048
  ds_read_b128 v[128:131], v5 offset:0
  ds_read_b128 v[132:135], v5 offset:1024
  ds_read_b64 v[152:153], v7 offset:4608
  ds_read_b128 v[144:147], v5 offset:2560
  ds_read_b128 v[148:151], v5 offset:3584
  s_waitcnt vmcnt(0)
  s_waitcnt lgkmcnt(3)
  v_min_f32 v192, v32, v137
  v_sub_f32 v193, v192, v32
  v_sub_f32 v194, v192, v137
  v_exp_f32 v193, v193
  v_exp_f32 v194, v194
  v_mul_f32 v192, v104, v193
  v_fma_f32 v192, v136, v194, v192
  v_rcp_f32 v192, v192
  s_nop 0
  v_mul_f32 v193, v193, v192
  v_mul_f32 v194, v194, v192
  v_mul_f32 v96, v96, v193
  v_mul_f32 v97, v97, v193
  v_mul_f32 v98, v98, v193
  v_mul_f32 v99, v99, v193
  v_mul_f32 v100, v100, v193
  v_mul_f32 v101, v101, v193
  v_mul_f32 v102, v102, v193
  v_mul_f32 v103, v103, v193
  v_fma_f32 v96, v128, v194, v96
  v_fma_f32 v97, v129, v194, v97
  v_fma_f32 v98, v130, v194, v98
  v_fma_f32 v99, v131, v194, v99
  v_fma_f32 v100, v132, v194, v100
  v_fma_f32 v101, v133, v194, v101
  v_fma_f32 v102, v134, v194, v102
  v_fma_f32 v103, v135, v194, v103
  v_cvt_pk_bf16_f32 v196, v96, v97
  v_cvt_pk_bf16_f32 v197, v98, v99
  v_cvt_pk_bf16_f32 v198, v100, v101
  v_cvt_pk_bf16_f32 v199, v102, v103
  buffer_store_dwordx4 v[196:199], v244, s[36:39], s64 offen sc1
  s_waitcnt lgkmcnt(0)
  v_min_f32 v200, v48, v153
  v_sub_f32 v201, v200, v48
  v_sub_f32 v202, v200, v153
  v_exp_f32 v201, v201
  v_exp_f32 v202, v202
  v_mul_f32 v200, v120, v201
  v_fma_f32 v200, v152, v202, v200
  v_rcp_f32 v200, v200
  s_nop 0
  v_mul_f32 v201, v201, v200
  v_mul_f32 v202, v202, v200
  v_mul_f32 v112, v112, v201
  v_mul_f32 v113, v113, v201
  v_mul_f32 v114, v114, v201
  v_mul_f32 v115, v115, v201
  v_mul_f32 v116, v116, v201
  v_mul_f32 v117, v117, v201
  v_mul_f32 v118, v118, v201
  v_mul_f32 v119, v119, v201
  v_fma_f32 v112, v144, v202, v112
  v_fma_f32 v113, v145, v202, v113
PADa_42:
  s_cbranch_execz RETa
  v_fma_f32 v114, v146, v202, v114
  v_fma_f32 v115, v147, v202, v115
  v_fma_f32 v116, v148, v202, v116
  v_fma_f32 v117, v149, v202, v117
  v_fma_f32 v118, v150, v202, v118
  v_fma_f32 v119, v151, v202, v119
  v_cvt_pk_bf16_f32 v204, v112, v113
  v_cvt_pk_bf16_f32 v205, v114, v115
  v_cvt_pk_bf16_f32 v206, v116, v117
  v_cvt_pk_bf16_f32 v207, v118, v119
  buffer_store_dwordx4 v[204:207], v244, s[36:39], s65 offen sc1
  s_waitcnt vmcnt(0)
  s_mov_b64 exec, 3
  buffer_store_dwordx2 v[14:15], v13, s[36:39], s66 offen sc1
  s_mov_b64 exec, -1
  v_mov_b32 v10, 4
  ds_write_b32 v8, v10
  s_waitcnt lgkmcnt(0)
  s_endpgm
LA_unsafe:
  s_cmp_eq_u32 s46, 1
  s_cbranch_scc1 LA_merge
  s_mov_b32 s46, 1
  s_waitcnt vmcnt(0) lgkmcnt(0)
  v_mov_b32 v32, 0xff800000
  v_mov_b32 v48, 0xff800000
  v_mov_b32 v64, 0xff800000
  v_mov_b32 v80, 0xff800000
  s_mov_b32 s43, s42
  s_mov_b32 s45, 0
LA_maxloop:
  buffer_load_dwordx4 v[192:195], v244, s[36:39], s43 offen offset:0 sc1
  s_waitcnt vmcnt(0)
  v_mfma_f32_32x32x16_bf16 v[96:111], v[192:195], v[16:19], 0
  v_mfma_f32_32x32x16_bf16 v[112:127], v[192:195], v[20:23], 0
  v_mfma_f32_32x32x16_bf16 v[128:143], v[192:195], v[24:27], 0
  v_mfma_f32_32x32x16_bf16 v[144:159], v[192:195], v[28:31], 0
  s_nop 11
  v_max3_f32 v32, v32, v96, v97
  v_max3_f32 v32, v32, v98, v99
  v_max3_f32 v32, v32, v100, v101
  v_max3_f32 v32, v32, v102, v103
  v_max3_f32 v32, v32, v104, v105
  v_max3_f32 v32, v32, v106, v107
  v_max3_f32 v32, v32, v108, v109
  v_max3_f32 v32, v32, v110, v111
  v_max3_f32 v48, v48, v112, v113
  v_max3_f32 v48, v48, v114, v115
  v_max3_f32 v48, v48, v116, v117
  v_max3_f32 v48, v48, v118, v119
  v_max3_f32 v48, v48, v120, v121
  v_max3_f32 v48, v48, v122, v123
  v_max3_f32 v48, v48, v124, v125
  v_max3_f32 v48, v48, v126, v127
  v_max3_f32 v64, v64, v128, v129
  v_max3_f32 v64, v64, v130, v131
  v_max3_f32 v64, v64, v132, v133
  v_max3_f32 v64, v64, v134, v135
  v_max3_f32 v64, v64, v136, v137
  v_max3_f32 v64, v64, v138, v139
  v_max3_f32 v64, v64, v140, v141
  v_max3_f32 v64, v64, v142, v143
  v_max3_f32 v80, v80, v144, v145
  v_max3_f32 v80, v80, v146, v147
  v_max3_f32 v80, v80, v148, v149
  v_max3_f32 v80, v80, v150, v151
  v_max3_f32 v80, v80, v152, v153
  v_max3_f32 v80, v80, v154, v155
  v_max3_f32 v80, v80, v156, v157
  v_max3_f32 v80, v80, v158, v159
  s_add_u32 s43, s43, 1024
  s_add_u32 s45, s45, 1
  s_cmp_lt_u32 s45, 32
  s_cbranch_scc1 LA_maxloop
  v_mov_b32 v33, v32
  v_mov_b32 v49, v48
  v_mov_b32 v65, v64
  v_mov_b32 v81, v80
  s_nop 0
  v_permlane32_swap_b32 v32, v33
  v_permlane32_swap_b32 v48, v49
  v_permlane32_swap_b32 v64, v65
  v_permlane32_swap_b32 v80, v81
  v_max_f32 v32, v32, v33
  v_max_f32 v48, v48, v49
  v_max_f32 v64, v64, v65
  v_max_f32 v80, v80, v81
  v_sub_f32 v32, 0, v32
  v_mov_b32 v33, v32
  v_pk_mov_b32 v[34:35], v[32:33], v[32:33] op_sel:[0,0]
  v_pk_mov_b32 v[36:37], v[32:33], v[32:33] op_sel:[0,0]
  v_pk_mov_b32 v[38:39], v[32:33], v[32:33] op_sel:[0,0]
  v_pk_mov_b32 v[40:41], v[32:33], v[32:33] op_sel:[0,0]
  v_pk_mov_b32 v[42:43], v[32:33], v[32:33] op_sel:[0,0]
  v_pk_mov_b32 v[44:45], v[32:33], v[32:33] op_sel:[0,0]
  v_pk_mov_b32 v[46:47], v[32:33], v[32:33] op_sel:[0,0]
  v_sub_f32 v48, 0, v48
  v_mov_b32 v49, v48
  v_pk_mov_b32 v[50:51], v[48:49], v[48:49] op_sel:[0,0]
  v_pk_mov_b32 v[52:53], v[48:49], v[48:49] op_sel:[0,0]
  v_pk_mov_b32 v[54:55], v[48:49], v[48:49] op_sel:[0,0]
  v_pk_mov_b32 v[56:57], v[48:49], v[48:49] op_sel:[0,0]
  v_pk_mov_b32 v[58:59], v[48:49], v[48:49] op_sel:[0,0]
  v_pk_mov_b32 v[60:61], v[48:49], v[48:49] op_sel:[0,0]
  v_pk_mov_b32 v[62:63], v[48:49], v[48:49] op_sel:[0,0]
  v_sub_f32 v64, 0, v64
  v_mov_b32 v65, v64
  v_pk_mov_b32 v[66:67], v[64:65], v[64:65] op_sel:[0,0]
  v_pk_mov_b32 v[68:69], v[64:65], v[64:65] op_sel:[0,0]
  v_pk_mov_b32 v[70:71], v[64:65], v[64:65] op_sel:[0,0]
  v_pk_mov_b32 v[72:73], v[64:65], v[64:65] op_sel:[0,0]
  v_pk_mov_b32 v[74:75], v[64:65], v[64:65] op_sel:[0,0]
  v_pk_mov_b32 v[76:77], v[64:65], v[64:65] op_sel:[0,0]
  v_pk_mov_b32 v[78:79], v[64:65], v[64:65] op_sel:[0,0]
  v_sub_f32 v80, 0, v80
  v_mov_b32 v81, v80
  v_pk_mov_b32 v[82:83], v[80:81], v[80:81] op_sel:[0,0]
  v_pk_mov_b32 v[84:85], v[80:81], v[80:81] op_sel:[0,0]
  v_pk_mov_b32 v[86:87], v[80:81], v[80:81] op_sel:[0,0]
  v_pk_mov_b32 v[88:89], v[80:81], v[80:81] op_sel:[0,0]
  v_pk_mov_b32 v[90:91], v[80:81], v[80:81] op_sel:[0,0]
  v_pk_mov_b32 v[92:93], v[80:81], v[80:81] op_sel:[0,0]
  v_pk_mov_b32 v[94:95], v[80:81], v[80:81] op_sel:[0,0]
  v_mov_b32 v96, 0
  v_mov_b32 v97, 0
  v_mov_b32 v98, 0
  v_mov_b32 v99, 0
  v_mov_b32 v100, 0
  v_mov_b32 v101, 0
  v_mov_b32 v102, 0
  v_mov_b32 v103, 0
  v_mov_b32 v104, 0
  v_mov_b32 v105, 0
  v_mov_b32 v106, 0
  v_mov_b32 v107, 0
  v_mov_b32 v108, 0
  v_mov_b32 v109, 0
  v_mov_b32 v110, 0
  v_mov_b32 v111, 0
  v_mov_b32 v112, 0
  v_mov_b32 v113, 0
  v_mov_b32 v114, 0
  v_mov_b32 v115, 0
  v_mov_b32 v116, 0
  v_mov_b32 v117, 0
  v_mov_b32 v118, 0
  v_mov_b32 v119, 0
  v_mov_b32 v120, 0
  v_mov_b32 v121, 0
  v_mov_b32 v122, 0
  v_mov_b32 v123, 0
  v_mov_b32 v124, 0
  v_mov_b32 v125, 0
  v_mov_b32 v126, 0
  v_mov_b32 v127, 0
  v_mov_b32 v128, 0
  v_mov_b32 v129, 0
  v_mov_b32 v130, 0
  v_mov_b32 v131, 0
  v_mov_b32 v132, 0
  v_mov_b32 v133, 0
  v_mov_b32 v134, 0
  v_mov_b32 v135, 0
  v_mov_b32 v136, 0
  v_mov_b32 v137, 0
  v_mov_b32 v138, 0
  v_mov_b32 v139, 0
  v_mov_b32 v140, 0
  v_mov_b32 v141, 0
  v_mov_b32 v142, 0
  v_mov_b32 v143, 0
  v_mov_b32 v144, 0
  v_mov_b32 v145, 0
  v_mov_b32 v146, 0
  v_mov_b32 v147, 0
  v_mov_b32 v148, 0
  v_mov_b32 v149, 0
  v_mov_b32 v150, 0
  v_mov_b32 v151, 0
  v_mov_b32 v152, 0
  v_mov_b32 v153, 0
  v_mov_b32 v154, 0
  v_mov_b32 v155, 0
  v_mov_b32 v156, 0
  v_mov_b32 v157, 0
  v_mov_b32 v158, 0
  v_mov_b32 v159, 0
  v_mov_b32 v184, 0
  v_mov_b32 v185, 0
  v_mov_b32 v186, 0
  v_mov_b32 v187, 0
  v_mov_b32 v188, 0
  v_mov_b32 v189, 0
  v_mov_b32 v190, 0
  v_mov_b32 v191, 0
  v_mov_b32 v236, 0
  v_mov_b32 v237, 0
  v_mov_b32 v238, 0
  v_mov_b32 v239, 0
  v_mad_u32_u24 v251, v250, s48, v245
  buffer_load_dwordx4 v[192:195], v244, s[36:39], s49 offen offset:0 sc1
  buffer_load_dwordx4 v[208:211], v251, s[36:39], s42 offen offset:0 sc1
  buffer_load_dwordx4 v[224:227], v251, s[36:39], s42 offen offset:512 sc1
  buffer_load_dwordx4 v[196:199], v244, s[36:39], s49 offen offset:1024 sc1
  buffer_load_dwordx4 v[212:215], v251, s[36:39], s42 offen offset:1024 sc1
  buffer_load_dwordx4 v[228:231], v251, s[36:39], s42 offen offset:1536 sc1
  buffer_load_dwordx4 v[200:203], v244, s[36:39], s49 offen offset:2048 sc1
  buffer_load_dwordx4 v[216:219], v251, s[36:39], s42 offen offset:2048 sc1
  buffer_load_dwordx4 v[232:235], v251, s[36:39], s42 offen offset:2560 sc1
  s_branch LA_restart
.p2align 6
L_G:
  s_getpc_b64 s[56:57]
L_pc:
  s_sub_u32 s56, s56, L_pc - parallel_sum__softmax_full_mha__glu_gated_reglu__prompt_kernel
  s_subb_u32 s57, s57, 0
  s_lshr_b32 s3, s2, 3
  s_lshl_b32 s3, s3, 2
  s_add_u32 s3, s3, s52
  s_lshl_b32 s3, s3, 9
  v_lshl_add_u32 v80, v0, 3, s3
  v_min_u32 v80, L_end - parallel_sum__softmax_full_mha__glu_gated_reglu__prompt_kernel - 4, v80
  v_mov_b32 v81, s57
  v_add_co_u32 v80, vcc, s56, v80
  s_nop 1
  v_addc_co_u32 v81, vcc, 0, v81, vcc
  global_load_dword v51, v[80:81], off
  v_lshlrev_b32 v1, 4, v0
  s_mov_b32 s62, 0x3f803f80
  s_lshl_b32 s3, s52, 12
  v_and_b32 v80, 31, v0
  v_lshrrev_b32 v81, 5, v0
  v_bfe_u32 v82, v0, 1, 3
  v_xor_b32 v82, v82, v81
  v_lshlrev_b32 v80, 7, v80
  v_add_u32 v80, s3, v80
  v_xor_b32 v83, 0, v82
  v_lshl_add_u32 v4, v83, 4, v80
  v_xor_b32 v83, 2, v82
  v_lshl_add_u32 v5, v83, 4, v80
  v_xor_b32 v83, 4, v82
  v_lshl_add_u32 v6, v83, 4, v80
  v_xor_b32 v83, 6, v82
  v_lshl_add_u32 v7, v83, 4, v80
  v_bfe_u32 v82, v0, 2, 2
  v_lshl_add_u32 v82, v81, 3, v82
  v_lshlrev_b32 v80, 7, v82
  v_and_b32 v83, 1, v0
  v_lshl_add_u32 v80, v83, 3, v80
  v_bfe_u32 v83, v0, 1, 1
  v_bfe_u32 v84, v0, 4, 1
  v_lshl_add_u32 v83, v84, 1, v83
  v_bfe_u32 v85, v0, 3, 1
  v_lshl_add_u32 v83, v85, 2, v83
  v_lshl_add_u32 v8, v83, 4, v80
  s_and_b32 s3, s52, 1
  s_lshl_b32 s3, s3, 6
  s_add_u32 s3, s3, 16384
  v_xor_b32 v8, s3, v8
  v_xor_b32 v9, 64, v8
  v_lshlrev_b32 v82, 6, v82
  v_lshl_add_u32 v82, v84, 5, v82
  v_and_b32 v83, 3, v0
  v_lshl_add_u32 v82, v83, 3, v82
  v_add_u32 v10, 98304, v82
  v_mov_b32 v80, 0
  v_mov_b32 v81, 0
  s_lshl_b32 s3, s52, 9
  s_add_u32 s3, s3, 160256
  v_lshl_add_u32 v82, v0, 3, s3
  ds_write_b64 v82, v[80:81]
  s_waitcnt lgkmcnt(0)
  s_mov_b32 s36, s22
  s_mov_b32 s37, s23
  s_mov_b32 s38, 18874368
  s_mov_b32 s39, 0x20000
  s_mov_b32 s72, s20
  s_mov_b32 s73, s21
  s_mov_b32 s74, 256
  s_mov_b32 s75, 0x20000
  s_or_b32 s3, s2, s52
  s_cmp_lg_u32 s3, 0
  s_cbranch_scc1 L_notag
  s_memrealtime s[56:57]
  v_mov_b32 v80, 0
  s_waitcnt lgkmcnt(0)
  s_or_b32 s56, s56, 1
  v_mov_b32 v14, s56
  v_mov_b32 v15, s57
  s_mov_b64 exec, 1
  buffer_store_dwordx2 v[14:15], v80, s[72:75], 0 offen sc1
  s_mov_b64 exec, -1
L_notag:
  s_and_b32 s3, s52, 1
  s_cmp_eq_u32 s3, 0
  s_cselect_b32 s32, s12, s14
  s_cselect_b32 s33, s13, s15
  s_mov_b32 s34, 1835008
  s_mov_b32 s35, 0x20000
  s_mov_b32 s40, s16
  s_mov_b32 s41, s17
  s_mov_b32 s42, 1835008
  s_mov_b32 s43, 0x20000
  s_mov_b32 s44, s8
  s_mov_b32 s45, s9
  s_mov_b32 s46, 524288
  s_mov_b32 s47, 0x20000
  s_mov_b32 s48, s18
  s_mov_b32 s49, s19
  s_mov_b32 s50, 2097152
  s_mov_b32 s51, 0x20000
  s_mov_b32 s28, s6
  s_mov_b32 s29, s7
  s_mov_b32 s30, 1572864
  s_mov_b32 s31, 0x20000
  s_lshr_b32 s3, s52, 1
  s_mul_i32 s63, s3, 114688
  s_lshl_b32 s71, s3, 12
  s_mul_i32 s61, s3, 3072
  s_mul_i32 s3, s54, 96
  s_add_u32 s64, s63, s3
  s_add_u32 s64, s64, 2048
  s_lshl_b32 s3, s54, 7
  s_add_u32 s63, s63, s3
  s_and_b32 s3, s52, 1
  s_lshl_b32 s56, s3, 13
  s_add_u32 s71, s71, s56
  s_mul_i32 s3, s3, 6272
  s_add_u32 s61, s61, s3
  s_lshl_b32 s69, s53, 2
  s_add_u32 s69, s69, s52
  s_lshl_b32 s3, s69, 10
  s_lshl_b32 s65, s54, 17
  s_add_u32 s65, s65, s3
  s_add_u32 s66, s65, 65536
  s_add_u32 s67, s65, 2097152
  s_add_u32 s58, s66, 2097152
  s_mul_i32 s3, s52, 5120
  s_add_u32 s3, s3, 32768
  v_and_b32 v80, 31, v0
  v_mul_u32_u24 v80, 40, v80
  v_lshrrev_b32 v81, 5, v0
  v_lshl_add_u32 v80, v81, 3, v80
  v_add_u32 v11, s3, v80
  v_lshrrev_b32 v80, 4, v0
  v_bfe_u32 v81, v0, 2, 2
  v_lshl_add_u32 v80, v80, 3, v81
  v_mul_u32_u24 v80, 40, v80
  v_and_b32 v81, 3, v0
  v_lshl_add_u32 v80, v81, 3, v80
  v_add_u32 v12, s3, v80
  s_and_b32 s3, s69, 31
  s_cbranch_scc1 L_noones
  s_lshr_b32 s3, s69, 5
  s_lshl_b32 s68, s54, 1
  s_add_u32 s3, s3, s68
  s_lshl_b32 s3, s3, 12
  s_add_u32 s68, s3, 4194304
  v_and_b32 v13, 7, v0
  v_lshlrev_b32 v13, 9, v13
  v_mov_b32 v52, s62
  v_mov_b32 v53, s62
  v_mov_b32 v54, s62
  v_mov_b32 v55, s62
  buffer_store_dwordx4 v[52:55], v13, s[36:39], s68 offen sc1
L_noones:
  v_mov_b32 v2, 0
  v_mov_b32 v3, 0
  v_mov_b32 v13, 0
  s_and_b32 s3, s52, 1
  s_lshl_b32 s3, s3, 7
  s_add_u32 s3, s3, 159744
  v_lshrrev_b32 v80, 5, v0
  v_lshl_add_u32 v62, v80, 4, s3
  v_and_b32 v80, 31, v0
  v_lshl_add_u32 v63, v80, 2, s3
  s_barrier
  s_setprio 2
  ds_read_b128 v[128:131], v4 offset:0
  ds_read_b64_tr_b16 v[64:65], v8 offset:0
  ds_read_b64_tr_b16 v[66:67], v8 offset:512
  ds_read_b64_tr_b16 v[68:69], v9 offset:0
  ds_read_b64_tr_b16 v[70:71], v9 offset:512
  ds_read_b128 v[132:135], v5 offset:0
  ds_read_b64_tr_b16 v[72:73], v8 offset:2048
  ds_read_b64_tr_b16 v[74:75], v8 offset:2560
  ds_read_b64_tr_b16 v[76:77], v9 offset:2048
  ds_read_b64_tr_b16 v[78:79], v9 offset:2560
  ds_read_b128 v[136:139], v6 offset:0
  ds_read_b64_tr_b16 v[80:81], v8 offset:4096
  ds_read_b64_tr_b16 v[82:83], v8 offset:4608
  ds_read_b64_tr_b16 v[84:85], v9 offset:4096
  ds_read_b64_tr_b16 v[86:87], v9 offset:4608
  s_waitcnt lgkmcnt(10)
  ds_read_b128 v[140:143], v7 offset:0
  ds_read_b64_tr_b16 v[88:89], v8 offset:6144
  ds_read_b64_tr_b16 v[90:91], v8 offset:6656
  ds_read_b64_tr_b16 v[92:93], v9 offset:6144
  ds_read_b64_tr_b16 v[94:95], v9 offset:6656
  s_barrier
  v_mfma_f32_32x32x16_bf16 v[16:31], v[64:67], v[128:131], 0
  ds_read_b128 v[144:147], v4 offset:24576
  ds_read_b64_tr_b16 v[96:97], v8 offset:24576
  v_mfma_f32_32x32x16_bf16 v[32:47], v[68:71], v[128:131], 0
  ds_read_b64_tr_b16 v[98:99], v8 offset:25088
  ds_read_b64_tr_b16 v[100:101], v9 offset:24576
  ds_read_b64_tr_b16 v[102:103], v9 offset:25088
  s_waitcnt lgkmcnt(15)
  v_mfma_f32_32x32x16_bf16 v[16:31], v[72:75], v[132:135], v[16:31]
  ds_read_b128 v[148:151], v5 offset:24576
  ds_read_b64_tr_b16 v[104:105], v8 offset:26624
  v_mfma_f32_32x32x16_bf16 v[32:47], v[76:79], v[132:135], v[32:47]
  ds_read_b64_tr_b16 v[106:107], v8 offset:27136
  ds_read_b64_tr_b16 v[108:109], v9 offset:26624
  ds_read_b64_tr_b16 v[110:111], v9 offset:27136
  s_waitcnt lgkmcnt(15)
  v_mfma_f32_32x32x16_bf16 v[16:31], v[80:83], v[136:139], v[16:31]
  ds_read_b128 v[152:155], v6 offset:24576
  ds_read_b64_tr_b16 v[112:113], v8 offset:28672
  v_mfma_f32_32x32x16_bf16 v[32:47], v[84:87], v[136:139], v[32:47]
  ds_read_b64_tr_b16 v[114:115], v8 offset:29184
  ds_read_b64_tr_b16 v[116:117], v9 offset:28672
  ds_read_b64_tr_b16 v[118:119], v9 offset:29184
  s_waitcnt lgkmcnt(15)
  v_mfma_f32_32x32x16_bf16 v[16:31], v[88:91], v[140:143], v[16:31]
  ds_read_b128 v[156:159], v7 offset:24576
  ds_read_b64_tr_b16 v[120:121], v8 offset:30720
  v_mfma_f32_32x32x16_bf16 v[32:47], v[92:95], v[140:143], v[32:47]
  ds_read_b64_tr_b16 v[122:123], v8 offset:31232
  ds_read_b64_tr_b16 v[124:125], v9 offset:30720
  ds_read_b64_tr_b16 v[126:127], v9 offset:31232
  v_mov_b32 v48, 0
  buffer_load_dwordx2 v[14:15], v48, s[72:75], 0 offen sc1
  v_dot2c_f32_bf16 v3, v128, v128
  v_dot2c_f32_bf16 v2, s62, v128
  v_dot2c_f32_bf16 v13, s62, v64
  v_dot2c_f32_bf16 v3, v129, v129
  v_dot2c_f32_bf16 v2, s62, v129
  v_dot2c_f32_bf16 v13, s62, v65
  v_dot2c_f32_bf16 v3, v130, v130
  v_dot2c_f32_bf16 v2, s62, v130
  v_dot2c_f32_bf16 v13, s62, v66
  v_dot2c_f32_bf16 v3, v131, v131
  v_dot2c_f32_bf16 v2, s62, v131
  v_dot2c_f32_bf16 v13, s62, v67
  v_dot2c_f32_bf16 v3, v132, v132
  v_dot2c_f32_bf16 v2, s62, v132
  v_dot2c_f32_bf16 v13, s62, v72
  v_dot2c_f32_bf16 v3, v133, v133
  v_dot2c_f32_bf16 v2, s62, v133
  v_dot2c_f32_bf16 v13, s62, v73
  v_dot2c_f32_bf16 v3, v134, v134
  v_dot2c_f32_bf16 v2, s62, v134
  v_dot2c_f32_bf16 v13, s62, v74
  v_dot2c_f32_bf16 v3, v135, v135
  v_dot2c_f32_bf16 v2, s62, v135
  v_dot2c_f32_bf16 v13, s62, v75
  v_dot2c_f32_bf16 v3, v136, v136
  v_dot2c_f32_bf16 v2, s62, v136
  v_dot2c_f32_bf16 v13, s62, v80
  v_dot2c_f32_bf16 v3, v137, v137
  v_dot2c_f32_bf16 v2, s62, v137
  v_dot2c_f32_bf16 v13, s62, v81
  v_dot2c_f32_bf16 v3, v138, v138
  v_dot2c_f32_bf16 v2, s62, v138
  v_dot2c_f32_bf16 v13, s62, v82
  v_dot2c_f32_bf16 v3, v139, v139
  v_dot2c_f32_bf16 v2, s62, v139
  v_dot2c_f32_bf16 v13, s62, v83
  v_dot2c_f32_bf16 v3, v140, v140
  v_dot2c_f32_bf16 v2, s62, v140
  v_dot2c_f32_bf16 v13, s62, v88
  v_dot2c_f32_bf16 v3, v141, v141
  v_dot2c_f32_bf16 v2, s62, v141
  v_dot2c_f32_bf16 v13, s62, v89
  v_dot2c_f32_bf16 v3, v142, v142
  v_dot2c_f32_bf16 v2, s62, v142
  v_dot2c_f32_bf16 v13, s62, v90
  v_dot2c_f32_bf16 v3, v143, v143
  v_dot2c_f32_bf16 v2, s62, v143
  v_dot2c_f32_bf16 v13, s62, v91
  v_add_u32 v4, 49152, v4
  v_add_u32 v5, 49152, v5
  v_add_u32 v6, 49152, v6
  v_add_u32 v7, 49152, v7
  v_add_u32 v8, 49152, v8
  v_add_u32 v9, 49152, v9
  s_barrier
  s_waitcnt lgkmcnt(15)
  v_mfma_f32_32x32x16_bf16 v[16:31], v[96:99], v[144:147], v[16:31]
  ds_read_b128 v[160:163], v4 offset:0
  ds_read_b64_tr_b16 v[64:65], v8 offset:0
  v_mfma_f32_32x32x16_bf16 v[32:47], v[100:103], v[144:147], v[32:47]
  ds_read_b64_tr_b16 v[66:67], v8 offset:512
  ds_read_b64_tr_b16 v[68:69], v9 offset:0
  ds_read_b64_tr_b16 v[70:71], v9 offset:512
  s_waitcnt lgkmcnt(15)
  v_mfma_f32_32x32x16_bf16 v[16:31], v[104:107], v[148:151], v[16:31]
  ds_read_b128 v[164:167], v5 offset:0
  ds_read_b64_tr_b16 v[72:73], v8 offset:2048
  v_mfma_f32_32x32x16_bf16 v[32:47], v[108:111], v[148:151], v[32:47]
  ds_read_b64_tr_b16 v[74:75], v8 offset:2560
  ds_read_b64_tr_b16 v[76:77], v9 offset:2048
  ds_read_b64_tr_b16 v[78:79], v9 offset:2560
  s_waitcnt lgkmcnt(15)
  v_mfma_f32_32x32x16_bf16 v[16:31], v[112:115], v[152:155], v[16:31]
  ds_read_b128 v[168:171], v6 offset:0
  ds_read_b64_tr_b16 v[80:81], v8 offset:4096
  v_mfma_f32_32x32x16_bf16 v[32:47], v[116:119], v[152:155], v[32:47]
  ds_read_b64_tr_b16 v[82:83], v8 offset:4608
  ds_read_b64_tr_b16 v[84:85], v9 offset:4096
  ds_read_b64_tr_b16 v[86:87], v9 offset:4608
  s_waitcnt lgkmcnt(15)
  v_mfma_f32_32x32x16_bf16 v[16:31], v[120:123], v[156:159], v[16:31]
  ds_read_b128 v[172:175], v7 offset:0
  ds_read_b64_tr_b16 v[88:89], v8 offset:6144
  v_mfma_f32_32x32x16_bf16 v[32:47], v[124:127], v[156:159], v[32:47]
  ds_read_b64_tr_b16 v[90:91], v8 offset:6656
  ds_read_b64_tr_b16 v[92:93], v9 offset:6144
  ds_read_b64_tr_b16 v[94:95], v9 offset:6656
  v_dot2c_f32_bf16 v3, v144, v144
  v_dot2c_f32_bf16 v2, s62, v144
  v_dot2c_f32_bf16 v13, s62, v96
  v_dot2c_f32_bf16 v3, v145, v145
  v_dot2c_f32_bf16 v2, s62, v145
  v_dot2c_f32_bf16 v13, s62, v97
  v_dot2c_f32_bf16 v3, v146, v146
  v_dot2c_f32_bf16 v2, s62, v146
  v_dot2c_f32_bf16 v13, s62, v98
  v_dot2c_f32_bf16 v3, v147, v147
  v_dot2c_f32_bf16 v2, s62, v147
  v_dot2c_f32_bf16 v13, s62, v99
  v_dot2c_f32_bf16 v3, v148, v148
  v_dot2c_f32_bf16 v2, s62, v148
  v_dot2c_f32_bf16 v13, s62, v104
  v_dot2c_f32_bf16 v3, v149, v149
  v_dot2c_f32_bf16 v2, s62, v149
  v_dot2c_f32_bf16 v13, s62, v105
  v_dot2c_f32_bf16 v3, v150, v150
  v_dot2c_f32_bf16 v2, s62, v150
  v_dot2c_f32_bf16 v13, s62, v106
  v_dot2c_f32_bf16 v3, v151, v151
  v_dot2c_f32_bf16 v2, s62, v151
  v_dot2c_f32_bf16 v13, s62, v107
  v_dot2c_f32_bf16 v3, v152, v152
  v_dot2c_f32_bf16 v2, s62, v152
  v_dot2c_f32_bf16 v13, s62, v112
  v_dot2c_f32_bf16 v3, v153, v153
  v_dot2c_f32_bf16 v2, s62, v153
  v_dot2c_f32_bf16 v13, s62, v113
  v_dot2c_f32_bf16 v3, v154, v154
  v_dot2c_f32_bf16 v2, s62, v154
  v_dot2c_f32_bf16 v13, s62, v114
  v_dot2c_f32_bf16 v3, v155, v155
  v_dot2c_f32_bf16 v2, s62, v155
  v_dot2c_f32_bf16 v13, s62, v115
  v_dot2c_f32_bf16 v3, v156, v156
  v_dot2c_f32_bf16 v2, s62, v156
  v_dot2c_f32_bf16 v13, s62, v120
  v_dot2c_f32_bf16 v3, v157, v157
  v_dot2c_f32_bf16 v2, s62, v157
  v_dot2c_f32_bf16 v13, s62, v121
  v_dot2c_f32_bf16 v3, v158, v158
  v_dot2c_f32_bf16 v2, s62, v158
  v_dot2c_f32_bf16 v13, s62, v122
  v_dot2c_f32_bf16 v3, v159, v159
  v_dot2c_f32_bf16 v2, s62, v159
  v_dot2c_f32_bf16 v13, s62, v123
  s_barrier
  s_waitcnt lgkmcnt(15)
  v_mfma_f32_32x32x16_bf16 v[16:31], v[64:67], v[160:163], v[16:31]
  ds_read_b128 v[176:179], v4 offset:24576
  ds_read_b64_tr_b16 v[96:97], v8 offset:24576
  v_mfma_f32_32x32x16_bf16 v[32:47], v[68:71], v[160:163], v[32:47]
  ds_read_b64_tr_b16 v[98:99], v8 offset:25088
  ds_read_b64_tr_b16 v[100:101], v9 offset:24576
  ds_read_b64_tr_b16 v[102:103], v9 offset:25088
  s_waitcnt lgkmcnt(15)
  v_mfma_f32_32x32x16_bf16 v[16:31], v[72:75], v[164:167], v[16:31]
  ds_read_b128 v[180:183], v5 offset:24576
  ds_read_b64_tr_b16 v[104:105], v8 offset:26624
  v_mfma_f32_32x32x16_bf16 v[32:47], v[76:79], v[164:167], v[32:47]
  ds_read_b64_tr_b16 v[106:107], v8 offset:27136
  ds_read_b64_tr_b16 v[108:109], v9 offset:26624
  ds_read_b64_tr_b16 v[110:111], v9 offset:27136
  s_waitcnt lgkmcnt(15)
  v_mfma_f32_32x32x16_bf16 v[16:31], v[80:83], v[168:171], v[16:31]
  ds_read_b128 v[184:187], v6 offset:24576
  ds_read_b64_tr_b16 v[112:113], v8 offset:28672
  v_mfma_f32_32x32x16_bf16 v[32:47], v[84:87], v[168:171], v[32:47]
  ds_read_b64_tr_b16 v[114:115], v8 offset:29184
  ds_read_b64_tr_b16 v[116:117], v9 offset:28672
  ds_read_b64_tr_b16 v[118:119], v9 offset:29184
  s_waitcnt lgkmcnt(15)
  v_mfma_f32_32x32x16_bf16 v[16:31], v[88:91], v[172:175], v[16:31]
  ds_read_b128 v[188:191], v7 offset:24576
  ds_read_b64_tr_b16 v[120:121], v8 offset:30720
  v_mfma_f32_32x32x16_bf16 v[32:47], v[92:95], v[172:175], v[32:47]
  ds_read_b64_tr_b16 v[122:123], v8 offset:31232
  ds_read_b64_tr_b16 v[124:125], v9 offset:30720
  ds_read_b64_tr_b16 v[126:127], v9 offset:31232
  v_dot2c_f32_bf16 v3, v160, v160
  v_dot2c_f32_bf16 v2, s62, v160
  v_dot2c_f32_bf16 v13, s62, v64
  v_dot2c_f32_bf16 v3, v161, v161
  v_dot2c_f32_bf16 v2, s62, v161
  v_dot2c_f32_bf16 v13, s62, v65
  v_dot2c_f32_bf16 v3, v162, v162
  v_dot2c_f32_bf16 v2, s62, v162
  v_dot2c_f32_bf16 v13, s62, v66
  v_dot2c_f32_bf16 v3, v163, v163
  v_dot2c_f32_bf16 v2, s62, v163
  v_dot2c_f32_bf16 v13, s62, v67
  v_dot2c_f32_bf16 v3, v164, v164
  v_dot2c_f32_bf16 v2, s62, v164
  v_dot2c_f32_bf16 v13, s62, v72
  v_dot2c_f32_bf16 v3, v165, v165
  v_dot2c_f32_bf16 v2, s62, v165
  v_dot2c_f32_bf16 v13, s62, v73
  v_dot2c_f32_bf16 v3, v166, v166
  v_dot2c_f32_bf16 v2, s62, v166
  v_dot2c_f32_bf16 v13, s62, v74
  v_dot2c_f32_bf16 v3, v167, v167
  v_dot2c_f32_bf16 v2, s62, v167
  v_dot2c_f32_bf16 v13, s62, v75
  v_dot2c_f32_bf16 v3, v168, v168
  v_dot2c_f32_bf16 v2, s62, v168
  v_dot2c_f32_bf16 v13, s62, v80
  v_dot2c_f32_bf16 v3, v169, v169
  v_dot2c_f32_bf16 v2, s62, v169
  v_dot2c_f32_bf16 v13, s62, v81
  v_dot2c_f32_bf16 v3, v170, v170
  v_dot2c_f32_bf16 v2, s62, v170
  v_dot2c_f32_bf16 v13, s62, v82
  v_dot2c_f32_bf16 v3, v171, v171
  v_dot2c_f32_bf16 v2, s62, v171
  v_dot2c_f32_bf16 v13, s62, v83
  v_dot2c_f32_bf16 v3, v172, v172
  v_dot2c_f32_bf16 v2, s62, v172
  v_dot2c_f32_bf16 v13, s62, v88
  v_dot2c_f32_bf16 v3, v173, v173
  v_dot2c_f32_bf16 v2, s62, v173
  v_dot2c_f32_bf16 v13, s62, v89
  v_dot2c_f32_bf16 v3, v174, v174
  v_dot2c_f32_bf16 v2, s62, v174
  v_dot2c_f32_bf16 v13, s62, v90
  v_dot2c_f32_bf16 v3, v175, v175
  v_dot2c_f32_bf16 v2, s62, v175
  v_dot2c_f32_bf16 v13, s62, v91
  v_subrev_u32 v4, 49152, v4
  v_subrev_u32 v5, 49152, v5
  v_subrev_u32 v6, 49152, v6
  v_subrev_u32 v7, 49152, v7
  v_subrev_u32 v8, 49152, v8
  v_subrev_u32 v9, 49152, v9
  s_barrier
  s_waitcnt lgkmcnt(15)
  v_mfma_f32_32x32x16_bf16 v[16:31], v[96:99], v[176:179], v[16:31]
  ds_read_b128 v[192:195], v4 offset:0
  ds_read_b64_tr_b16 v[64:65], v8 offset:0
  v_mfma_f32_32x32x16_bf16 v[32:47], v[100:103], v[176:179], v[32:47]
  ds_read_b64_tr_b16 v[66:67], v8 offset:512
  ds_read_b64_tr_b16 v[68:69], v9 offset:0
  ds_read_b64_tr_b16 v[70:71], v9 offset:512
  s_waitcnt lgkmcnt(15)
  v_mfma_f32_32x32x16_bf16 v[16:31], v[104:107], v[180:183], v[16:31]
  ds_read_b128 v[196:199], v5 offset:0
  ds_read_b64_tr_b16 v[72:73], v8 offset:2048
  v_mfma_f32_32x32x16_bf16 v[32:47], v[108:111], v[180:183], v[32:47]
  ds_read_b64_tr_b16 v[74:75], v8 offset:2560
  ds_read_b64_tr_b16 v[76:77], v9 offset:2048
  ds_read_b64_tr_b16 v[78:79], v9 offset:2560
  s_waitcnt lgkmcnt(15)
  v_mfma_f32_32x32x16_bf16 v[16:31], v[112:115], v[184:187], v[16:31]
  ds_read_b128 v[200:203], v6 offset:0
  ds_read_b64_tr_b16 v[80:81], v8 offset:4096
  v_mfma_f32_32x32x16_bf16 v[32:47], v[116:119], v[184:187], v[32:47]
  ds_read_b64_tr_b16 v[82:83], v8 offset:4608
  ds_read_b64_tr_b16 v[84:85], v9 offset:4096
  ds_read_b64_tr_b16 v[86:87], v9 offset:4608
  s_waitcnt lgkmcnt(15)
  v_mfma_f32_32x32x16_bf16 v[16:31], v[120:123], v[188:191], v[16:31]
  ds_read_b128 v[204:207], v7 offset:0
  ds_read_b64_tr_b16 v[88:89], v8 offset:6144
  v_mfma_f32_32x32x16_bf16 v[32:47], v[124:127], v[188:191], v[32:47]
  ds_read_b64_tr_b16 v[90:91], v8 offset:6656
  ds_read_b64_tr_b16 v[92:93], v9 offset:6144
  ds_read_b64_tr_b16 v[94:95], v9 offset:6656
  v_dot2c_f32_bf16 v3, v176, v176
  v_dot2c_f32_bf16 v2, s62, v176
  v_dot2c_f32_bf16 v13, s62, v96
  v_dot2c_f32_bf16 v3, v177, v177
  v_dot2c_f32_bf16 v2, s62, v177
  v_dot2c_f32_bf16 v13, s62, v97
  v_dot2c_f32_bf16 v3, v178, v178
  v_dot2c_f32_bf16 v2, s62, v178
  v_dot2c_f32_bf16 v13, s62, v98
  v_dot2c_f32_bf16 v3, v179, v179
  v_dot2c_f32_bf16 v2, s62, v179
  v_dot2c_f32_bf16 v13, s62, v99
  v_dot2c_f32_bf16 v3, v180, v180
  v_dot2c_f32_bf16 v2, s62, v180
  v_dot2c_f32_bf16 v13, s62, v104
  v_dot2c_f32_bf16 v3, v181, v181
  v_dot2c_f32_bf16 v2, s62, v181
  v_dot2c_f32_bf16 v13, s62, v105
  v_dot2c_f32_bf16 v3, v182, v182
  v_dot2c_f32_bf16 v2, s62, v182
  v_dot2c_f32_bf16 v13, s62, v106
  v_dot2c_f32_bf16 v3, v183, v183
  v_dot2c_f32_bf16 v2, s62, v183
  v_dot2c_f32_bf16 v13, s62, v107
  v_dot2c_f32_bf16 v3, v184, v184
  v_dot2c_f32_bf16 v2, s62, v184
  v_dot2c_f32_bf16 v13, s62, v112
  v_dot2c_f32_bf16 v3, v185, v185
  v_dot2c_f32_bf16 v2, s62, v185
  v_dot2c_f32_bf16 v13, s62, v113
  v_dot2c_f32_bf16 v3, v186, v186
  v_dot2c_f32_bf16 v2, s62, v186
  v_dot2c_f32_bf16 v13, s62, v114
  v_dot2c_f32_bf16 v3, v187, v187
  v_dot2c_f32_bf16 v2, s62, v187
  v_dot2c_f32_bf16 v13, s62, v115
  v_dot2c_f32_bf16 v3, v188, v188
  v_dot2c_f32_bf16 v2, s62, v188
  v_dot2c_f32_bf16 v13, s62, v120
  v_dot2c_f32_bf16 v3, v189, v189
  v_dot2c_f32_bf16 v2, s62, v189
  v_dot2c_f32_bf16 v13, s62, v121
  v_dot2c_f32_bf16 v3, v190, v190
  v_dot2c_f32_bf16 v2, s62, v190
  v_dot2c_f32_bf16 v13, s62, v122
  v_dot2c_f32_bf16 v3, v191, v191
  v_dot2c_f32_bf16 v2, s62, v191
  v_dot2c_f32_bf16 v13, s62, v123
  s_barrier
  s_waitcnt lgkmcnt(15)
  v_mfma_f32_32x32x16_bf16 v[16:31], v[64:67], v[192:195], v[16:31]
  ds_read_b128 v[208:211], v4 offset:24576
  ds_read_b64_tr_b16 v[96:97], v8 offset:24576
  v_mfma_f32_32x32x16_bf16 v[32:47], v[68:71], v[192:195], v[32:47]
  ds_read_b64_tr_b16 v[98:99], v8 offset:25088
  ds_read_b64_tr_b16 v[100:101], v9 offset:24576
  ds_read_b64_tr_b16 v[102:103], v9 offset:25088
  s_waitcnt lgkmcnt(15)
  v_mfma_f32_32x32x16_bf16 v[16:31], v[72:75], v[196:199], v[16:31]
  ds_read_b128 v[212:215], v5 offset:24576
  ds_read_b64_tr_b16 v[104:105], v8 offset:26624
  v_mfma_f32_32x32x16_bf16 v[32:47], v[76:79], v[196:199], v[32:47]
  ds_read_b64_tr_b16 v[106:107], v8 offset:27136
  ds_read_b64_tr_b16 v[108:109], v9 offset:26624
  ds_read_b64_tr_b16 v[110:111], v9 offset:27136
  s_waitcnt lgkmcnt(15)
  v_mfma_f32_32x32x16_bf16 v[16:31], v[80:83], v[200:203], v[16:31]
  ds_read_b128 v[216:219], v6 offset:24576
  ds_read_b64_tr_b16 v[112:113], v8 offset:28672
  v_mfma_f32_32x32x16_bf16 v[32:47], v[84:87], v[200:203], v[32:47]
  ds_read_b64_tr_b16 v[114:115], v8 offset:29184
  ds_read_b64_tr_b16 v[116:117], v9 offset:28672
  ds_read_b64_tr_b16 v[118:119], v9 offset:29184
  s_waitcnt lgkmcnt(15)
  v_mfma_f32_32x32x16_bf16 v[16:31], v[88:91], v[204:207], v[16:31]
  ds_read_b128 v[220:223], v7 offset:24576
  ds_read_b64_tr_b16 v[120:121], v8 offset:30720
  v_mfma_f32_32x32x16_bf16 v[32:47], v[92:95], v[204:207], v[32:47]
  ds_read_b64_tr_b16 v[122:123], v8 offset:31232
  ds_read_b64_tr_b16 v[124:125], v9 offset:30720
  ds_read_b64_tr_b16 v[126:127], v9 offset:31232
  v_dot2c_f32_bf16 v3, v192, v192
  v_dot2c_f32_bf16 v2, s62, v192
  v_dot2c_f32_bf16 v13, s62, v64
  v_dot2c_f32_bf16 v3, v193, v193
  v_dot2c_f32_bf16 v2, s62, v193
  v_dot2c_f32_bf16 v13, s62, v65
  v_dot2c_f32_bf16 v3, v194, v194
  v_dot2c_f32_bf16 v2, s62, v194
  v_dot2c_f32_bf16 v13, s62, v66
  v_dot2c_f32_bf16 v3, v195, v195
  v_dot2c_f32_bf16 v2, s62, v195
  v_dot2c_f32_bf16 v13, s62, v67
  v_dot2c_f32_bf16 v3, v196, v196
  v_dot2c_f32_bf16 v2, s62, v196
  v_dot2c_f32_bf16 v13, s62, v72
  v_dot2c_f32_bf16 v3, v197, v197
  v_dot2c_f32_bf16 v2, s62, v197
  v_dot2c_f32_bf16 v13, s62, v73
  v_dot2c_f32_bf16 v3, v198, v198
  v_dot2c_f32_bf16 v2, s62, v198
  v_dot2c_f32_bf16 v13, s62, v74
  v_dot2c_f32_bf16 v3, v199, v199
  v_dot2c_f32_bf16 v2, s62, v199
  v_dot2c_f32_bf16 v13, s62, v75
  v_dot2c_f32_bf16 v3, v200, v200
  v_dot2c_f32_bf16 v2, s62, v200
  v_dot2c_f32_bf16 v13, s62, v80
  v_dot2c_f32_bf16 v3, v201, v201
  v_dot2c_f32_bf16 v2, s62, v201
  v_dot2c_f32_bf16 v13, s62, v81
  v_dot2c_f32_bf16 v3, v202, v202
  v_dot2c_f32_bf16 v2, s62, v202
  v_dot2c_f32_bf16 v13, s62, v82
  v_dot2c_f32_bf16 v3, v203, v203
  v_dot2c_f32_bf16 v2, s62, v203
  v_dot2c_f32_bf16 v13, s62, v83
  v_dot2c_f32_bf16 v3, v204, v204
  v_dot2c_f32_bf16 v2, s62, v204
  v_dot2c_f32_bf16 v13, s62, v88
  v_dot2c_f32_bf16 v3, v205, v205
  v_dot2c_f32_bf16 v2, s62, v205
  v_dot2c_f32_bf16 v13, s62, v89
  v_dot2c_f32_bf16 v3, v206, v206
  v_dot2c_f32_bf16 v2, s62, v206
  v_dot2c_f32_bf16 v13, s62, v90
  v_dot2c_f32_bf16 v3, v207, v207
  v_dot2c_f32_bf16 v2, s62, v207
  v_dot2c_f32_bf16 v13, s62, v91
  v_add_u32 v4, 49152, v4
  v_add_u32 v5, 49152, v5
  v_add_u32 v6, 49152, v6
  v_add_u32 v7, 49152, v7
  v_add_u32 v8, 49152, v8
  v_add_u32 v9, 49152, v9
  s_barrier
  s_waitcnt lgkmcnt(15)
  v_mfma_f32_32x32x16_bf16 v[16:31], v[96:99], v[208:211], v[16:31]
  ds_read_b128 v[224:227], v4 offset:0
  ds_read_b64_tr_b16 v[64:65], v8 offset:0
  v_mfma_f32_32x32x16_bf16 v[32:47], v[100:103], v[208:211], v[32:47]
  ds_read_b64_tr_b16 v[66:67], v8 offset:512
  ds_read_b64_tr_b16 v[68:69], v9 offset:0
  ds_read_b64_tr_b16 v[70:71], v9 offset:512
  s_waitcnt lgkmcnt(15)
  v_mfma_f32_32x32x16_bf16 v[16:31], v[104:107], v[212:215], v[16:31]
  ds_read_b128 v[228:231], v5 offset:0
  ds_read_b64_tr_b16 v[72:73], v8 offset:2048
  v_mfma_f32_32x32x16_bf16 v[32:47], v[108:111], v[212:215], v[32:47]
  ds_read_b64_tr_b16 v[74:75], v8 offset:2560
  ds_read_b64_tr_b16 v[76:77], v9 offset:2048
  ds_read_b64_tr_b16 v[78:79], v9 offset:2560
  s_waitcnt lgkmcnt(15)
  v_mfma_f32_32x32x16_bf16 v[16:31], v[112:115], v[216:219], v[16:31]
  ds_read_b128 v[232:235], v6 offset:0
  ds_read_b64_tr_b16 v[80:81], v8 offset:4096
  v_mfma_f32_32x32x16_bf16 v[32:47], v[116:119], v[216:219], v[32:47]
  ds_read_b64_tr_b16 v[82:83], v8 offset:4608
  ds_read_b64_tr_b16 v[84:85], v9 offset:4096
  ds_read_b64_tr_b16 v[86:87], v9 offset:4608
  s_waitcnt lgkmcnt(15)
  v_mfma_f32_32x32x16_bf16 v[16:31], v[120:123], v[220:223], v[16:31]
  ds_read_b128 v[236:239], v7 offset:0
  ds_read_b64_tr_b16 v[88:89], v8 offset:6144
  v_mfma_f32_32x32x16_bf16 v[32:47], v[124:127], v[220:223], v[32:47]
  ds_read_b64_tr_b16 v[90:91], v8 offset:6656
  ds_read_b64_tr_b16 v[92:93], v9 offset:6144
  ds_read_b64_tr_b16 v[94:95], v9 offset:6656
  s_waitcnt vmcnt(0)
  v_cmp_ne_u64 vcc, 0, v[14:15]
  s_nop 0
  s_cmp_eq_u64 vcc, -1
  s_cbranch_scc1 tag8
  v_mov_b32 v48, 0
poll9:
  buffer_load_dwordx2 v[14:15], v48, s[72:75], 0 offen sc1
  s_waitcnt vmcnt(0)
  v_cmp_ne_u64 vcc, 0, v[14:15]
  s_cmp_eq_u32 s70, 0
  s_cbranch_scc1 poll9_out
  s_sub_u32 s70, s70, 1
  s_cmp_eq_u64 vcc, -1
  s_cbranch_scc0 poll9
poll9_out:
tag8:
  v_dot2c_f32_bf16 v3, v208, v208
  v_dot2c_f32_bf16 v2, s62, v208
  v_dot2c_f32_bf16 v13, s62, v96
  v_dot2c_f32_bf16 v3, v209, v209
  v_dot2c_f32_bf16 v2, s62, v209
  v_dot2c_f32_bf16 v13, s62, v97
  v_dot2c_f32_bf16 v3, v210, v210
  v_dot2c_f32_bf16 v2, s62, v210
  v_dot2c_f32_bf16 v13, s62, v98
  v_dot2c_f32_bf16 v3, v211, v211
  v_dot2c_f32_bf16 v2, s62, v211
  v_dot2c_f32_bf16 v13, s62, v99
  v_dot2c_f32_bf16 v3, v212, v212
  v_dot2c_f32_bf16 v2, s62, v212
  v_dot2c_f32_bf16 v13, s62, v104
  v_dot2c_f32_bf16 v3, v213, v213
  v_dot2c_f32_bf16 v2, s62, v213
  v_dot2c_f32_bf16 v13, s62, v105
  v_dot2c_f32_bf16 v3, v214, v214
  v_dot2c_f32_bf16 v2, s62, v214
  v_dot2c_f32_bf16 v13, s62, v106
  v_dot2c_f32_bf16 v3, v215, v215
  v_dot2c_f32_bf16 v2, s62, v215
  v_dot2c_f32_bf16 v13, s62, v107
  v_dot2c_f32_bf16 v3, v216, v216
  v_dot2c_f32_bf16 v2, s62, v216
  v_dot2c_f32_bf16 v13, s62, v112
  v_dot2c_f32_bf16 v3, v217, v217
  v_dot2c_f32_bf16 v2, s62, v217
  v_dot2c_f32_bf16 v13, s62, v113
  v_dot2c_f32_bf16 v3, v218, v218
  v_dot2c_f32_bf16 v2, s62, v218
  v_dot2c_f32_bf16 v13, s62, v114
  v_dot2c_f32_bf16 v3, v219, v219
  v_dot2c_f32_bf16 v2, s62, v219
  v_dot2c_f32_bf16 v13, s62, v115
  v_dot2c_f32_bf16 v3, v220, v220
  v_dot2c_f32_bf16 v2, s62, v220
  v_dot2c_f32_bf16 v13, s62, v120
  v_dot2c_f32_bf16 v3, v221, v221
  v_dot2c_f32_bf16 v2, s62, v221
  v_dot2c_f32_bf16 v13, s62, v121
  v_dot2c_f32_bf16 v3, v222, v222
  v_dot2c_f32_bf16 v2, s62, v222
  v_dot2c_f32_bf16 v13, s62, v122
  v_dot2c_f32_bf16 v3, v223, v223
  v_dot2c_f32_bf16 v2, s62, v223
  v_dot2c_f32_bf16 v13, s62, v123
  s_barrier
  s_waitcnt lgkmcnt(15)
  v_mfma_f32_32x32x16_bf16 v[16:31], v[64:67], v[224:227], v[16:31]
  ds_read_b128 v[240:243], v4 offset:24576
  ds_read_b64_tr_b16 v[96:97], v8 offset:24576
  v_mfma_f32_32x32x16_bf16 v[32:47], v[68:71], v[224:227], v[32:47]
  ds_read_b64_tr_b16 v[98:99], v8 offset:25088
  ds_read_b64_tr_b16 v[100:101], v9 offset:24576
  ds_read_b64_tr_b16 v[102:103], v9 offset:25088
  s_waitcnt lgkmcnt(15)
  v_mfma_f32_32x32x16_bf16 v[16:31], v[72:75], v[228:231], v[16:31]
  ds_read_b128 v[244:247], v5 offset:24576
  ds_read_b64_tr_b16 v[104:105], v8 offset:26624
  v_mfma_f32_32x32x16_bf16 v[32:47], v[76:79], v[228:231], v[32:47]
  ds_read_b64_tr_b16 v[106:107], v8 offset:27136
  ds_read_b64_tr_b16 v[108:109], v9 offset:26624
  ds_read_b64_tr_b16 v[110:111], v9 offset:27136
  s_waitcnt lgkmcnt(15)
  v_mfma_f32_32x32x16_bf16 v[16:31], v[80:83], v[232:235], v[16:31]
  ds_read_b128 v[248:251], v6 offset:24576
  ds_read_b64_tr_b16 v[112:113], v8 offset:28672
  v_mfma_f32_32x32x16_bf16 v[32:47], v[84:87], v[232:235], v[32:47]
  ds_read_b64_tr_b16 v[114:115], v8 offset:29184
  ds_read_b64_tr_b16 v[116:117], v9 offset:28672
  ds_read_b64_tr_b16 v[118:119], v9 offset:29184
  s_waitcnt lgkmcnt(15)
  v_mfma_f32_32x32x16_bf16 v[16:31], v[88:91], v[236:239], v[16:31]
  ds_read_b128 v[252:255], v7 offset:24576
  ds_read_b64_tr_b16 v[120:121], v8 offset:30720
  v_mfma_f32_32x32x16_bf16 v[32:47], v[92:95], v[236:239], v[32:47]
  ds_read_b64_tr_b16 v[122:123], v8 offset:31232
  ds_read_b64_tr_b16 v[124:125], v9 offset:30720
  ds_read_b64_tr_b16 v[126:127], v9 offset:31232
  v_dot2c_f32_bf16 v3, v224, v224
  v_dot2c_f32_bf16 v2, s62, v224
  v_dot2c_f32_bf16 v13, s62, v64
  v_dot2c_f32_bf16 v3, v225, v225
  v_dot2c_f32_bf16 v2, s62, v225
  v_dot2c_f32_bf16 v13, s62, v65
  v_dot2c_f32_bf16 v3, v226, v226
  v_dot2c_f32_bf16 v2, s62, v226
  v_dot2c_f32_bf16 v13, s62, v66
  v_dot2c_f32_bf16 v3, v227, v227
  v_dot2c_f32_bf16 v2, s62, v227
  v_dot2c_f32_bf16 v13, s62, v67
  v_dot2c_f32_bf16 v3, v228, v228
  v_dot2c_f32_bf16 v2, s62, v228
  v_dot2c_f32_bf16 v13, s62, v72
  v_dot2c_f32_bf16 v3, v229, v229
  v_dot2c_f32_bf16 v2, s62, v229
  v_dot2c_f32_bf16 v13, s62, v73
  v_dot2c_f32_bf16 v3, v230, v230
  v_dot2c_f32_bf16 v2, s62, v230
  v_dot2c_f32_bf16 v13, s62, v74
  v_dot2c_f32_bf16 v3, v231, v231
  v_dot2c_f32_bf16 v2, s62, v231
  v_dot2c_f32_bf16 v13, s62, v75
  v_dot2c_f32_bf16 v3, v232, v232
  v_dot2c_f32_bf16 v2, s62, v232
  v_dot2c_f32_bf16 v13, s62, v80
  v_dot2c_f32_bf16 v3, v233, v233
  v_dot2c_f32_bf16 v2, s62, v233
  v_dot2c_f32_bf16 v13, s62, v81
  v_dot2c_f32_bf16 v3, v234, v234
  v_dot2c_f32_bf16 v2, s62, v234
  v_dot2c_f32_bf16 v13, s62, v82
  v_dot2c_f32_bf16 v3, v235, v235
  v_dot2c_f32_bf16 v2, s62, v235
  v_dot2c_f32_bf16 v13, s62, v83
  v_dot2c_f32_bf16 v3, v236, v236
  v_dot2c_f32_bf16 v2, s62, v236
  v_dot2c_f32_bf16 v13, s62, v88
  v_dot2c_f32_bf16 v3, v237, v237
  v_dot2c_f32_bf16 v2, s62, v237
  v_dot2c_f32_bf16 v13, s62, v89
  v_dot2c_f32_bf16 v3, v238, v238
  v_dot2c_f32_bf16 v2, s62, v238
  v_dot2c_f32_bf16 v13, s62, v90
  v_dot2c_f32_bf16 v3, v239, v239
  v_dot2c_f32_bf16 v2, s62, v239
  v_dot2c_f32_bf16 v13, s62, v91
  s_waitcnt lgkmcnt(15)
  v_dot2c_f32_bf16 v3, v240, v240
  v_dot2c_f32_bf16 v2, s62, v240
  v_dot2c_f32_bf16 v13, s62, v96
  v_dot2c_f32_bf16 v3, v241, v241
  v_dot2c_f32_bf16 v2, s62, v241
  v_dot2c_f32_bf16 v13, s62, v97
  v_dot2c_f32_bf16 v3, v242, v242
  v_dot2c_f32_bf16 v2, s62, v242
  v_dot2c_f32_bf16 v13, s62, v98
  v_dot2c_f32_bf16 v3, v243, v243
  v_dot2c_f32_bf16 v2, s62, v243
  v_dot2c_f32_bf16 v13, s62, v99
  s_waitcnt lgkmcnt(10)
  v_dot2c_f32_bf16 v3, v244, v244
  v_dot2c_f32_bf16 v2, s62, v244
  v_dot2c_f32_bf16 v13, s62, v104
  v_dot2c_f32_bf16 v3, v245, v245
  v_dot2c_f32_bf16 v2, s62, v245
  v_dot2c_f32_bf16 v13, s62, v105
  v_dot2c_f32_bf16 v3, v246, v246
  v_dot2c_f32_bf16 v2, s62, v246
  v_dot2c_f32_bf16 v13, s62, v106
  v_dot2c_f32_bf16 v3, v247, v247
  v_dot2c_f32_bf16 v2, s62, v247
  v_dot2c_f32_bf16 v13, s62, v107
  s_waitcnt lgkmcnt(5)
  v_dot2c_f32_bf16 v3, v248, v248
  v_dot2c_f32_bf16 v2, s62, v248
  v_dot2c_f32_bf16 v13, s62, v112
  v_dot2c_f32_bf16 v3, v249, v249
  v_dot2c_f32_bf16 v2, s62, v249
  v_dot2c_f32_bf16 v13, s62, v113
  v_dot2c_f32_bf16 v3, v250, v250
  v_dot2c_f32_bf16 v2, s62, v250
  v_dot2c_f32_bf16 v13, s62, v114
  v_dot2c_f32_bf16 v3, v251, v251
  v_dot2c_f32_bf16 v2, s62, v251
  v_dot2c_f32_bf16 v13, s62, v115
  s_waitcnt lgkmcnt(0)
  v_dot2c_f32_bf16 v3, v252, v252
  v_dot2c_f32_bf16 v2, s62, v252
  v_dot2c_f32_bf16 v13, s62, v120
  v_dot2c_f32_bf16 v3, v253, v253
  v_dot2c_f32_bf16 v2, s62, v253
  v_dot2c_f32_bf16 v13, s62, v121
  v_dot2c_f32_bf16 v3, v254, v254
  v_dot2c_f32_bf16 v2, s62, v254
  v_dot2c_f32_bf16 v13, s62, v122
  v_dot2c_f32_bf16 v3, v255, v255
  v_dot2c_f32_bf16 v2, s62, v255
  v_dot2c_f32_bf16 v13, s62, v123
  s_lshl_b32 s3, s52, 8
  s_add_u32 s3, s3, 160256
  v_mov_b32 v56, v2
  v_mov_b32 v58, v13
  v_mov_b32 v57, v3
  v_permlane32_swap_b32 v2, v56
  v_permlane32_swap_b32 v13, v58
  v_permlane32_swap_b32 v3, v57
  v_add_f32 v58, v13, v58
  ds_write_b32 v63, v58
  v_xor_b32 v63, 128, v62
  v_lshl_add_u32 v4, v0, 2, s3
  v_mov_b32 v6, 1
  v_mfma_f32_32x32x16_bf16 v[16:31], v[96:99], v[240:243], v[16:31]
  v_and_b32 v58, 3, v0
  v_lshlrev_b32 v58, 8, v58
  v_and_b32 v59, 60, v0
  v_add_u32 v58, v58, v59
  v_add_u32 v5, 160256, v58
  s_waitcnt lgkmcnt(0)
  ds_write_b32 v4, v6
  v_mfma_f32_32x32x16_bf16 v[32:47], v[100:103], v[240:243], v[32:47]
  ds_read_b32 v7, v5
  v_mfma_f32_32x32x16_bf16 v[16:31], v[104:107], v[244:247], v[16:31]
  v_add_f32 v2, v2, v56
  v_add_f32 v3, v3, v57
  v_mul_f32 v2, 0x3b000000, v2
  v_mfma_f32_32x32x16_bf16 v[32:47], v[108:111], v[244:247], v[32:47]
  s_waitcnt lgkmcnt(0)
  v_cmp_le_u32 vcc, 1, v7
  s_nop 0
  s_cmp_eq_u64 vcc, -1
  s_cbranch_scc0 sig10_slow
sig10_ok:
  ds_read_b128 v[64:67], v62 offset:0
  ds_read_b128 v[68:71], v62 offset:32
  ds_read_b128 v[72:75], v62 offset:64
  ds_read_b128 v[76:79], v62 offset:96
  ds_read_b128 v[80:83], v63 offset:0
  ds_read_b128 v[84:87], v63 offset:32
  ds_read_b128 v[88:91], v63 offset:64
  ds_read_b128 v[92:95], v63 offset:96
  v_mfma_f32_32x32x16_bf16 v[16:31], v[112:115], v[248:251], v[16:31]
  v_mul_f32 v3, 0x3b000000, v3
  v_fma_f32 v3, -v2, v2, v3
  v_max_f32 v3, 0, v3
  v_mfma_f32_32x32x16_bf16 v[32:47], v[116:119], v[248:251], v[32:47]
  v_add_f32 v3, 0x3727c5ac, v3
  v_rsq_f32 v60, v3
  s_nop 0
  v_mfma_f32_32x32x16_bf16 v[16:31], v[120:123], v[252:255], v[16:31]
  v_mul_f32 v61, -v2, v60
  v_mfma_f32_32x32x16_bf16 v[32:47], v[124:127], v[252:255], v[32:47]
  s_lshl_b32 s57, s52, 11
  s_add_u32 s57, s57, 53248
  v_add_u32 v59, s57, v1
  s_bitcmp1_b32 s52, 0
  s_cbranch_scc1 L_vout
  s_waitcnt lgkmcnt(0)
  v_mul_f32 v80, v61, v80
  v_mul_f32 v81, v61, v81
  v_mul_f32 v82, v61, v82
  v_mul_f32 v83, v61, v83
  v_mul_f32 v84, v61, v84
  v_mul_f32 v85, v61, v85
  v_mul_f32 v86, v61, v86
  v_mul_f32 v87, v61, v87
  v_mul_f32 v88, v61, v88
  v_mul_f32 v89, v61, v89
  v_mul_f32 v90, v61, v90
  v_mul_f32 v91, v61, v91
  v_mul_f32 v92, v61, v92
  v_mul_f32 v93, v61, v93
  v_mul_f32 v94, v61, v94
  v_mul_f32 v95, v61, v95
  v_fma_f32 v32, v32, v60, v80
  v_fma_f32 v33, v33, v60, v81
  v_fma_f32 v34, v34, v60, v82
  v_fma_f32 v35, v35, v60, v83
  v_fma_f32 v36, v36, v60, v84
  v_fma_f32 v37, v37, v60, v85
  v_fma_f32 v38, v38, v60, v86
  v_fma_f32 v39, v39, v60, v87
  v_fma_f32 v40, v40, v60, v88
  v_fma_f32 v41, v41, v60, v89
  v_fma_f32 v42, v42, v60, v90
  v_fma_f32 v43, v43, v60, v91
  v_fma_f32 v44, v44, v60, v92
  v_fma_f32 v45, v45, v60, v93
  v_fma_f32 v46, v46, v60, v94
  v_fma_f32 v47, v47, v60, v95
  v_cvt_pk_bf16_f32 v32, v32, v33
  v_cvt_pk_bf16_f32 v33, v34, v35
  v_cvt_pk_bf16_f32 v34, v36, v37
  v_cvt_pk_bf16_f32 v35, v38, v39
  v_cvt_pk_bf16_f32 v36, v40, v41
  v_cvt_pk_bf16_f32 v37, v42, v43
  v_cvt_pk_bf16_f32 v38, v44, v45
  v_cvt_pk_bf16_f32 v39, v46, v47
  ds_write_b64 v11, v[32:33] offset:0
  ds_write_b64 v11, v[34:35] offset:16
  ds_write_b64 v11, v[36:37] offset:1280
  ds_write_b64 v11, v[38:39] offset:1296
  v_mul_f32 v64, v61, v64
  v_mul_f32 v65, v61, v65
  v_mul_f32 v66, v61, v66
  v_mul_f32 v67, v61, v67
  v_mul_f32 v68, v61, v68
  v_mul_f32 v69, v61, v69
  v_mul_f32 v70, v61, v70
  v_mul_f32 v71, v61, v71
  v_mul_f32 v72, v61, v72
  v_mul_f32 v73, v61, v73
  v_mul_f32 v74, v61, v74
  v_mul_f32 v75, v61, v75
  v_mul_f32 v76, v61, v76
  v_mul_f32 v77, v61, v77
  v_mul_f32 v78, v61, v78
  v_mul_f32 v79, v61, v79
  s_waitcnt lgkmcnt(0)
  ds_read_b64_tr_b16 v[96:97], v12 offset:0
  ds_read_b64_tr_b16 v[98:99], v12 offset:160
  ds_read_b64_tr_b16 v[100:101], v12 offset:1280
  ds_read_b64_tr_b16 v[102:103], v12 offset:1440
  v_fma_f32 v16, v16, v60, v64
  v_fma_f32 v17, v17, v60, v65
  v_fma_f32 v18, v18, v60, v66
  v_fma_f32 v19, v19, v60, v67
  v_fma_f32 v20, v20, v60, v68
  v_fma_f32 v21, v21, v60, v69
  v_fma_f32 v22, v22, v60, v70
  v_fma_f32 v23, v23, v60, v71
  v_fma_f32 v24, v24, v60, v72
  v_fma_f32 v25, v25, v60, v73
  v_fma_f32 v26, v26, v60, v74
  v_fma_f32 v27, v27, v60, v75
  v_fma_f32 v28, v28, v60, v76
  v_fma_f32 v29, v29, v60, v77
  v_fma_f32 v30, v30, v60, v78
  v_fma_f32 v31, v31, v60, v79
  v_cvt_pk_bf16_f32 v16, v16, v17
  v_cvt_pk_bf16_f32 v17, v18, v19
  v_cvt_pk_bf16_f32 v18, v20, v21
  v_cvt_pk_bf16_f32 v19, v22, v23
  v_cvt_pk_bf16_f32 v20, v24, v25
  v_cvt_pk_bf16_f32 v21, v26, v27
  v_cvt_pk_bf16_f32 v22, v28, v29
  v_cvt_pk_bf16_f32 v23, v30, v31
  s_waitcnt lgkmcnt(2)
  buffer_store_dwordx4 v[96:99], v1, s[36:39], s67 offen sc1
  s_waitcnt lgkmcnt(0)
  buffer_store_dwordx4 v[100:103], v1, s[36:39], s58 offen sc1
  buffer_store_dwordx4 v[16:19], v1, s[36:39], s65 offen sc1
  buffer_store_dwordx4 v[20:23], v1, s[36:39], s66 offen sc1
  ds_write_b128 v59, v[16:19] offset:0
  ds_write_b128 v59, v[20:23] offset:1024
  s_branch L_kvout
L_vout:
  s_waitcnt lgkmcnt(0)
  v_mul_f32 v64, v61, v64
  v_mul_f32 v65, v61, v65
  v_mul_f32 v66, v61, v66
  v_mul_f32 v67, v61, v67
  v_mul_f32 v68, v61, v68
  v_mul_f32 v69, v61, v69
  v_mul_f32 v70, v61, v70
  v_mul_f32 v71, v61, v71
  v_mul_f32 v72, v61, v72
  v_mul_f32 v73, v61, v73
  v_mul_f32 v74, v61, v74
  v_mul_f32 v75, v61, v75
  v_mul_f32 v76, v61, v76
  v_mul_f32 v77, v61, v77
  v_mul_f32 v78, v61, v78
  v_mul_f32 v79, v61, v79
  v_fma_f32 v16, v16, v60, v64
  v_fma_f32 v17, v17, v60, v65
  v_fma_f32 v18, v18, v60, v66
  v_fma_f32 v19, v19, v60, v67
  v_fma_f32 v20, v20, v60, v68
  v_fma_f32 v21, v21, v60, v69
  v_fma_f32 v22, v22, v60, v70
  v_fma_f32 v23, v23, v60, v71
  v_fma_f32 v24, v24, v60, v72
  v_fma_f32 v25, v25, v60, v73
  v_fma_f32 v26, v26, v60, v74
  v_fma_f32 v27, v27, v60, v75
  v_fma_f32 v28, v28, v60, v76
  v_fma_f32 v29, v29, v60, v77
  v_fma_f32 v30, v30, v60, v78
  v_fma_f32 v31, v31, v60, v79
  v_cvt_pk_bf16_f32 v16, v16, v17
  v_cvt_pk_bf16_f32 v17, v18, v19
  v_cvt_pk_bf16_f32 v18, v20, v21
  v_cvt_pk_bf16_f32 v19, v22, v23
  v_cvt_pk_bf16_f32 v20, v24, v25
  v_cvt_pk_bf16_f32 v21, v26, v27
  v_cvt_pk_bf16_f32 v22, v28, v29
  v_cvt_pk_bf16_f32 v23, v30, v31
  ds_write_b64 v11, v[16:17] offset:0
  ds_write_b64 v11, v[18:19] offset:16
  ds_write_b64 v11, v[20:21] offset:1280
  ds_write_b64 v11, v[22:23] offset:1296
  v_mul_f32 v80, v61, v80
  v_mul_f32 v81, v61, v81
  v_mul_f32 v82, v61, v82
  v_mul_f32 v83, v61, v83
  v_mul_f32 v84, v61, v84
  v_mul_f32 v85, v61, v85
  v_mul_f32 v86, v61, v86
  v_mul_f32 v87, v61, v87
  v_mul_f32 v88, v61, v88
  v_mul_f32 v89, v61, v89
  v_mul_f32 v90, v61, v90
  v_mul_f32 v91, v61, v91
  v_mul_f32 v92, v61, v92
  v_mul_f32 v93, v61, v93
  v_mul_f32 v94, v61, v94
  v_mul_f32 v95, v61, v95
  s_waitcnt lgkmcnt(0)
  ds_read_b64_tr_b16 v[96:97], v12 offset:0
  ds_read_b64_tr_b16 v[98:99], v12 offset:160
  ds_read_b64_tr_b16 v[100:101], v12 offset:1280
  ds_read_b64_tr_b16 v[102:103], v12 offset:1440
  v_fma_f32 v32, v32, v60, v80
  v_fma_f32 v33, v33, v60, v81
  v_fma_f32 v34, v34, v60, v82
  v_fma_f32 v35, v35, v60, v83
  v_fma_f32 v36, v36, v60, v84
  v_fma_f32 v37, v37, v60, v85
  v_fma_f32 v38, v38, v60, v86
  v_fma_f32 v39, v39, v60, v87
  v_fma_f32 v40, v40, v60, v88
  v_fma_f32 v41, v41, v60, v89
  v_fma_f32 v42, v42, v60, v90
  v_fma_f32 v43, v43, v60, v91
  v_fma_f32 v44, v44, v60, v92
  v_fma_f32 v45, v45, v60, v93
  v_fma_f32 v46, v46, v60, v94
  v_fma_f32 v47, v47, v60, v95
  v_cvt_pk_bf16_f32 v32, v32, v33
  v_cvt_pk_bf16_f32 v33, v34, v35
  v_cvt_pk_bf16_f32 v34, v36, v37
  v_cvt_pk_bf16_f32 v35, v38, v39
  v_cvt_pk_bf16_f32 v36, v40, v41
  v_cvt_pk_bf16_f32 v37, v42, v43
  v_cvt_pk_bf16_f32 v38, v44, v45
  v_cvt_pk_bf16_f32 v39, v46, v47
  s_waitcnt lgkmcnt(2)
  buffer_store_dwordx4 v[96:99], v1, s[36:39], s67 offen sc1
  s_waitcnt lgkmcnt(0)
  buffer_store_dwordx4 v[100:103], v1, s[36:39], s58 offen sc1
  buffer_store_dwordx4 v[32:35], v1, s[36:39], s65 offen sc1
  buffer_store_dwordx4 v[36:39], v1, s[36:39], s66 offen sc1
  ds_write_b128 v59, v[32:35] offset:0
  ds_write_b128 v59, v[36:39] offset:1024
L_kvout:
  s_lshl_b32 s3, s54, 6
  s_add_u32 s3, s3, s69
  s_lshl_b32 s3, s3, 7
  s_add_u32 s59, s3, 6291456
  v_cvt_pk_bf16_f32 v82, v60, 0
  v_lshlrev_b32 v83, 16, v82
  v_rcp_f32 v85, v60
  v_rcp_f32 v80, v83
  v_mul_f32 v84, v61, v85
  v_mul_f32 v95, v60, v80
  v_mul_f32 v84, v84, v83
  v_mov_b32 v73, 0
  v_and_b32 v80, 3, v0
  v_lshlrev_b32 v80, 8, v80
  v_add_u32 v72, 161280, v80
  v_mov_b32 v6, 2
.p2align 3
  v_dot2_f32_bf16 v64, v128, v82, v84
  v_dot2_f32_bf16 v65, v128, v83, v84
  v_dot2_f32_bf16 v66, v129, v82, v84
  v_dot2_f32_bf16 v67, v129, v83, v84
  v_dot2_f32_bf16 v68, v130, v82, v84
  v_dot2_f32_bf16 v69, v130, v83, v84
  v_cvt_pk_bf16_f32 v128, v64, v65
  v_dot2_f32_bf16 v70, v131, v82, v84
  v_dot2_f32_bf16 v71, v131, v83, v84
  v_cvt_pk_bf16_f32 v129, v66, v67
  v_dot2_f32_bf16 v64, v132, v82, v84
  v_dot2_f32_bf16 v65, v132, v83, v84
  v_cvt_pk_bf16_f32 v130, v68, v69
  v_dot2_f32_bf16 v66, v133, v82, v84
  v_dot2_f32_bf16 v67, v133, v83, v84
  v_cvt_pk_bf16_f32 v131, v70, v71
  v_dot2_f32_bf16 v68, v134, v82, v84
  v_dot2_f32_bf16 v69, v134, v83, v84
  v_cvt_pk_bf16_f32 v132, v64, v65
  v_dot2_f32_bf16 v70, v135, v82, v84
  v_dot2_f32_bf16 v71, v135, v83, v84
  v_cvt_pk_bf16_f32 v133, v66, v67
  v_dot2_f32_bf16 v64, v136, v82, v84
  v_dot2_f32_bf16 v65, v136, v83, v84
  v_cvt_pk_bf16_f32 v134, v68, v69
  v_dot2_f32_bf16 v66, v137, v82, v84
  v_dot2_f32_bf16 v67, v137, v83, v84
  v_cvt_pk_bf16_f32 v135, v70, v71
  v_dot2_f32_bf16 v68, v138, v82, v84
  v_dot2_f32_bf16 v69, v138, v83, v84
  v_cvt_pk_bf16_f32 v136, v64, v65
  v_dot2_f32_bf16 v70, v139, v82, v84
  v_dot2_f32_bf16 v71, v139, v83, v84
  v_cvt_pk_bf16_f32 v137, v66, v67
  v_dot2_f32_bf16 v64, v140, v82, v84
  v_dot2_f32_bf16 v65, v140, v83, v84
  v_cvt_pk_bf16_f32 v138, v68, v69
  v_dot2_f32_bf16 v66, v141, v82, v84
  v_dot2_f32_bf16 v67, v141, v83, v84
  v_cvt_pk_bf16_f32 v139, v70, v71
  v_dot2_f32_bf16 v68, v142, v82, v84
  v_dot2_f32_bf16 v69, v142, v83, v84
  v_cvt_pk_bf16_f32 v140, v64, v65
  v_dot2_f32_bf16 v70, v143, v82, v84
  v_dot2_f32_bf16 v71, v143, v83, v84
  v_cvt_pk_bf16_f32 v141, v66, v67
  v_dot2_f32_bf16 v64, v144, v82, v84
  v_dot2_f32_bf16 v65, v144, v83, v84
  v_cvt_pk_bf16_f32 v142, v68, v69
  v_dot2_f32_bf16 v66, v145, v82, v84
  v_dot2_f32_bf16 v67, v145, v83, v84
  v_cvt_pk_bf16_f32 v143, v70, v71
  v_dot2_f32_bf16 v68, v146, v82, v84
  v_dot2_f32_bf16 v69, v146, v83, v84
  v_cvt_pk_bf16_f32 v144, v64, v65
  v_dot2_f32_bf16 v70, v147, v82, v84
  v_dot2_f32_bf16 v71, v147, v83, v84
  v_cvt_pk_bf16_f32 v145, v66, v67
  v_dot2_f32_bf16 v64, v148, v82, v84
  v_dot2_f32_bf16 v65, v148, v83, v84
  v_cvt_pk_bf16_f32 v146, v68, v69
  v_dot2_f32_bf16 v66, v149, v82, v84
  v_dot2_f32_bf16 v67, v149, v83, v84
  v_cvt_pk_bf16_f32 v147, v70, v71
  v_dot2_f32_bf16 v68, v150, v82, v84
  v_dot2_f32_bf16 v69, v150, v83, v84
  v_cvt_pk_bf16_f32 v148, v64, v65
  v_dot2_f32_bf16 v70, v151, v82, v84
  v_dot2_f32_bf16 v71, v151, v83, v84
  v_cvt_pk_bf16_f32 v149, v66, v67
  v_dot2_f32_bf16 v64, v152, v82, v84
  v_dot2_f32_bf16 v65, v152, v83, v84
  v_cvt_pk_bf16_f32 v150, v68, v69
  v_dot2_f32_bf16 v66, v153, v82, v84
  v_dot2_f32_bf16 v67, v153, v83, v84
  v_cvt_pk_bf16_f32 v151, v70, v71
  v_dot2_f32_bf16 v68, v154, v82, v84
  v_dot2_f32_bf16 v69, v154, v83, v84
  v_cvt_pk_bf16_f32 v152, v64, v65
  v_dot2_f32_bf16 v70, v155, v82, v84
  v_dot2_f32_bf16 v71, v155, v83, v84
  v_cvt_pk_bf16_f32 v153, v66, v67
  v_dot2_f32_bf16 v64, v156, v82, v84
  v_dot2_f32_bf16 v65, v156, v83, v84
  v_cvt_pk_bf16_f32 v154, v68, v69
  v_dot2_f32_bf16 v66, v157, v82, v84
  v_dot2_f32_bf16 v67, v157, v83, v84
  v_cvt_pk_bf16_f32 v155, v70, v71
  v_dot2_f32_bf16 v68, v158, v82, v84
  v_dot2_f32_bf16 v69, v158, v83, v84
  v_cvt_pk_bf16_f32 v156, v64, v65
  v_dot2_f32_bf16 v70, v159, v82, v84
  v_dot2_f32_bf16 v71, v159, v83, v84
  v_cvt_pk_bf16_f32 v157, v66, v67
  v_dot2_f32_bf16 v64, v160, v82, v84
  v_dot2_f32_bf16 v65, v160, v83, v84
  v_cvt_pk_bf16_f32 v158, v68, v69
  v_dot2_f32_bf16 v66, v161, v82, v84
  v_dot2_f32_bf16 v67, v161, v83, v84
  v_cvt_pk_bf16_f32 v159, v70, v71
  v_dot2_f32_bf16 v68, v162, v82, v84
  v_dot2_f32_bf16 v69, v162, v83, v84
  v_cvt_pk_bf16_f32 v160, v64, v65
  v_dot2_f32_bf16 v70, v163, v82, v84
  v_dot2_f32_bf16 v71, v163, v83, v84
  v_cvt_pk_bf16_f32 v161, v66, v67
  v_dot2_f32_bf16 v64, v164, v82, v84
  v_dot2_f32_bf16 v65, v164, v83, v84
  v_cvt_pk_bf16_f32 v162, v68, v69
  v_dot2_f32_bf16 v66, v165, v82, v84
  v_dot2_f32_bf16 v67, v165, v83, v84
  v_cvt_pk_bf16_f32 v163, v70, v71
  v_dot2_f32_bf16 v68, v166, v82, v84
  v_dot2_f32_bf16 v69, v166, v83, v84
  v_cvt_pk_bf16_f32 v164, v64, v65
  v_dot2_f32_bf16 v70, v167, v82, v84
  v_dot2_f32_bf16 v71, v167, v83, v84
  v_cvt_pk_bf16_f32 v165, v66, v67
  v_dot2_f32_bf16 v64, v168, v82, v84
  v_dot2_f32_bf16 v65, v168, v83, v84
  v_cvt_pk_bf16_f32 v166, v68, v69
  v_dot2_f32_bf16 v66, v169, v82, v84
  v_dot2_f32_bf16 v67, v169, v83, v84
  v_cvt_pk_bf16_f32 v167, v70, v71
  v_dot2_f32_bf16 v68, v170, v82, v84
  v_dot2_f32_bf16 v69, v170, v83, v84
  v_cvt_pk_bf16_f32 v168, v64, v65
  v_dot2_f32_bf16 v70, v171, v82, v84
  v_dot2_f32_bf16 v71, v171, v83, v84
  v_cvt_pk_bf16_f32 v169, v66, v67
  v_dot2_f32_bf16 v64, v172, v82, v84
  v_dot2_f32_bf16 v65, v172, v83, v84
  v_cvt_pk_bf16_f32 v170, v68, v69
  v_dot2_f32_bf16 v66, v173, v82, v84
  v_dot2_f32_bf16 v67, v173, v83, v84
  v_cvt_pk_bf16_f32 v171, v70, v71
  v_dot2_f32_bf16 v68, v174, v82, v84
  v_dot2_f32_bf16 v69, v174, v83, v84
  v_cvt_pk_bf16_f32 v172, v64, v65
  v_dot2_f32_bf16 v70, v175, v82, v84
  v_dot2_f32_bf16 v71, v175, v83, v84
  v_cvt_pk_bf16_f32 v173, v66, v67
  v_dot2_f32_bf16 v64, v176, v82, v84
  v_dot2_f32_bf16 v65, v176, v83, v84
  v_cvt_pk_bf16_f32 v174, v68, v69
  v_dot2_f32_bf16 v66, v177, v82, v84
  v_dot2_f32_bf16 v67, v177, v83, v84
  v_cvt_pk_bf16_f32 v175, v70, v71
  v_dot2_f32_bf16 v68, v178, v82, v84
  v_dot2_f32_bf16 v69, v178, v83, v84
  v_cvt_pk_bf16_f32 v176, v64, v65
  v_dot2_f32_bf16 v70, v179, v82, v84
  v_dot2_f32_bf16 v71, v179, v83, v84
  v_cvt_pk_bf16_f32 v177, v66, v67
  v_dot2_f32_bf16 v64, v180, v82, v84
  v_dot2_f32_bf16 v65, v180, v83, v84
  v_cvt_pk_bf16_f32 v178, v68, v69
  v_dot2_f32_bf16 v66, v181, v82, v84
  v_dot2_f32_bf16 v67, v181, v83, v84
  v_cvt_pk_bf16_f32 v179, v70, v71
  v_dot2_f32_bf16 v68, v182, v82, v84
  v_dot2_f32_bf16 v69, v182, v83, v84
  v_cvt_pk_bf16_f32 v180, v64, v65
  v_dot2_f32_bf16 v70, v183, v82, v84
  v_dot2_f32_bf16 v71, v183, v83, v84
  v_cvt_pk_bf16_f32 v181, v66, v67
  v_dot2_f32_bf16 v64, v184, v82, v84
  v_dot2_f32_bf16 v65, v184, v83, v84
  v_cvt_pk_bf16_f32 v182, v68, v69
  v_dot2_f32_bf16 v66, v185, v82, v84
  v_dot2_f32_bf16 v67, v185, v83, v84
  v_cvt_pk_bf16_f32 v183, v70, v71
  v_dot2_f32_bf16 v68, v186, v82, v84
  v_dot2_f32_bf16 v69, v186, v83, v84
  v_cvt_pk_bf16_f32 v184, v64, v65
  v_dot2_f32_bf16 v70, v187, v82, v84
  v_dot2_f32_bf16 v71, v187, v83, v84
  v_cvt_pk_bf16_f32 v185, v66, v67
  v_dot2_f32_bf16 v64, v188, v82, v84
  v_dot2_f32_bf16 v65, v188, v83, v84
  v_cvt_pk_bf16_f32 v186, v68, v69
  v_dot2_f32_bf16 v66, v189, v82, v84
  v_dot2_f32_bf16 v67, v189, v83, v84
  v_cvt_pk_bf16_f32 v187, v70, v71
  v_dot2_f32_bf16 v68, v190, v82, v84
  v_dot2_f32_bf16 v69, v190, v83, v84
  v_cvt_pk_bf16_f32 v188, v64, v65
  v_dot2_f32_bf16 v70, v191, v82, v84
  v_dot2_f32_bf16 v71, v191, v83, v84
  v_cvt_pk_bf16_f32 v189, v66, v67
  v_dot2_f32_bf16 v64, v192, v82, v84
  v_dot2_f32_bf16 v65, v192, v83, v84
  v_cvt_pk_bf16_f32 v190, v68, v69
  v_dot2_f32_bf16 v66, v193, v82, v84
  v_dot2_f32_bf16 v67, v193, v83, v84
  v_cvt_pk_bf16_f32 v191, v70, v71
  v_dot2_f32_bf16 v68, v194, v82, v84
  v_dot2_f32_bf16 v69, v194, v83, v84
  v_cvt_pk_bf16_f32 v192, v64, v65
  v_dot2_f32_bf16 v70, v195, v82, v84
  v_dot2_f32_bf16 v71, v195, v83, v84
  v_cvt_pk_bf16_f32 v193, v66, v67
  s_waitcnt vmcnt(0)
  s_waitcnt lgkmcnt(0)
  s_mov_b64 exec, 1
  buffer_store_dwordx2 v[14:15], v73, s[36:39], s59 offen sc1
  s_mov_b64 exec, -1
  ds_write_b32 v4, v6
.p2align 3
  v_dot2_f32_bf16 v64, v196, v82, v84
  v_dot2_f32_bf16 v65, v196, v83, v84
  v_cvt_pk_bf16_f32 v194, v68, v69
  v_dot2_f32_bf16 v66, v197, v82, v84
  v_dot2_f32_bf16 v67, v197, v83, v84
  v_cvt_pk_bf16_f32 v195, v70, v71
  v_dot2_f32_bf16 v68, v198, v82, v84
  v_dot2_f32_bf16 v69, v198, v83, v84
  v_cvt_pk_bf16_f32 v196, v64, v65
  v_dot2_f32_bf16 v70, v199, v82, v84
  v_dot2_f32_bf16 v71, v199, v83, v84
  v_cvt_pk_bf16_f32 v197, v66, v67
  v_dot2_f32_bf16 v64, v200, v82, v84
  v_dot2_f32_bf16 v65, v200, v83, v84
  v_cvt_pk_bf16_f32 v198, v68, v69
  v_dot2_f32_bf16 v66, v201, v82, v84
  v_dot2_f32_bf16 v67, v201, v83, v84
  v_cvt_pk_bf16_f32 v199, v70, v71
  v_dot2_f32_bf16 v68, v202, v82, v84
  v_dot2_f32_bf16 v69, v202, v83, v84
  v_cvt_pk_bf16_f32 v200, v64, v65
  v_dot2_f32_bf16 v70, v203, v82, v84
  v_dot2_f32_bf16 v71, v203, v83, v84
  v_cvt_pk_bf16_f32 v201, v66, v67
  v_dot2_f32_bf16 v64, v204, v82, v84
  v_dot2_f32_bf16 v65, v204, v83, v84
  v_cvt_pk_bf16_f32 v202, v68, v69
  v_dot2_f32_bf16 v66, v205, v82, v84
  v_dot2_f32_bf16 v67, v205, v83, v84
  v_cvt_pk_bf16_f32 v203, v70, v71
  v_dot2_f32_bf16 v68, v206, v82, v84
  v_dot2_f32_bf16 v69, v206, v83, v84
  v_cvt_pk_bf16_f32 v204, v64, v65
  v_dot2_f32_bf16 v70, v207, v82, v84
  v_dot2_f32_bf16 v71, v207, v83, v84
  v_cvt_pk_bf16_f32 v205, v66, v67
  v_dot2_f32_bf16 v64, v208, v82, v84
  v_dot2_f32_bf16 v65, v208, v83, v84
  v_cvt_pk_bf16_f32 v206, v68, v69
  v_dot2_f32_bf16 v66, v209, v82, v84
  v_dot2_f32_bf16 v67, v209, v83, v84
  v_cvt_pk_bf16_f32 v207, v70, v71
  v_dot2_f32_bf16 v68, v210, v82, v84
  v_dot2_f32_bf16 v69, v210, v83, v84
  v_cvt_pk_bf16_f32 v208, v64, v65
  v_dot2_f32_bf16 v70, v211, v82, v84
  v_dot2_f32_bf16 v71, v211, v83, v84
  v_cvt_pk_bf16_f32 v209, v66, v67
  v_dot2_f32_bf16 v64, v212, v82, v84
  v_dot2_f32_bf16 v65, v212, v83, v84
  v_cvt_pk_bf16_f32 v210, v68, v69
  v_dot2_f32_bf16 v66, v213, v82, v84
  v_dot2_f32_bf16 v67, v213, v83, v84
  v_cvt_pk_bf16_f32 v211, v70, v71
  v_dot2_f32_bf16 v68, v214, v82, v84
  v_dot2_f32_bf16 v69, v214, v83, v84
  v_cvt_pk_bf16_f32 v212, v64, v65
  v_dot2_f32_bf16 v70, v215, v82, v84
  v_dot2_f32_bf16 v71, v215, v83, v84
  v_cvt_pk_bf16_f32 v213, v66, v67
  v_dot2_f32_bf16 v64, v216, v82, v84
  v_dot2_f32_bf16 v65, v216, v83, v84
  v_cvt_pk_bf16_f32 v214, v68, v69
  v_dot2_f32_bf16 v66, v217, v82, v84
  v_dot2_f32_bf16 v67, v217, v83, v84
  v_cvt_pk_bf16_f32 v215, v70, v71
  v_dot2_f32_bf16 v68, v218, v82, v84
  v_dot2_f32_bf16 v69, v218, v83, v84
  v_cvt_pk_bf16_f32 v216, v64, v65
  v_dot2_f32_bf16 v70, v219, v82, v84
  v_dot2_f32_bf16 v71, v219, v83, v84
  v_cvt_pk_bf16_f32 v217, v66, v67
  v_dot2_f32_bf16 v64, v220, v82, v84
  v_dot2_f32_bf16 v65, v220, v83, v84
  v_cvt_pk_bf16_f32 v218, v68, v69
  v_dot2_f32_bf16 v66, v221, v82, v84
  v_dot2_f32_bf16 v67, v221, v83, v84
  v_cvt_pk_bf16_f32 v219, v70, v71
  v_dot2_f32_bf16 v68, v222, v82, v84
  v_dot2_f32_bf16 v69, v222, v83, v84
  v_cvt_pk_bf16_f32 v220, v64, v65
  v_dot2_f32_bf16 v70, v223, v82, v84
  v_dot2_f32_bf16 v71, v223, v83, v84
  v_cvt_pk_bf16_f32 v221, v66, v67
  v_dot2_f32_bf16 v64, v224, v82, v84
  v_dot2_f32_bf16 v65, v224, v83, v84
  v_cvt_pk_bf16_f32 v222, v68, v69
  v_dot2_f32_bf16 v66, v225, v82, v84
  v_dot2_f32_bf16 v67, v225, v83, v84
  v_cvt_pk_bf16_f32 v223, v70, v71
  v_dot2_f32_bf16 v68, v226, v82, v84
  v_dot2_f32_bf16 v69, v226, v83, v84
  v_cvt_pk_bf16_f32 v224, v64, v65
  v_dot2_f32_bf16 v70, v227, v82, v84
  v_dot2_f32_bf16 v71, v227, v83, v84
  v_cvt_pk_bf16_f32 v225, v66, v67
  v_dot2_f32_bf16 v64, v228, v82, v84
  v_dot2_f32_bf16 v65, v228, v83, v84
  v_cvt_pk_bf16_f32 v226, v68, v69
  v_dot2_f32_bf16 v66, v229, v82, v84
  v_dot2_f32_bf16 v67, v229, v83, v84
  v_cvt_pk_bf16_f32 v227, v70, v71
  v_dot2_f32_bf16 v68, v230, v82, v84
  v_dot2_f32_bf16 v69, v230, v83, v84
  v_cvt_pk_bf16_f32 v228, v64, v65
  v_dot2_f32_bf16 v70, v231, v82, v84
  v_dot2_f32_bf16 v71, v231, v83, v84
  v_cvt_pk_bf16_f32 v229, v66, v67
  v_dot2_f32_bf16 v64, v232, v82, v84
  v_dot2_f32_bf16 v65, v232, v83, v84
  v_cvt_pk_bf16_f32 v230, v68, v69
  v_dot2_f32_bf16 v66, v233, v82, v84
  v_dot2_f32_bf16 v67, v233, v83, v84
  v_cvt_pk_bf16_f32 v231, v70, v71
  v_dot2_f32_bf16 v68, v234, v82, v84
  v_dot2_f32_bf16 v69, v234, v83, v84
  v_cvt_pk_bf16_f32 v232, v64, v65
  v_dot2_f32_bf16 v70, v235, v82, v84
  v_dot2_f32_bf16 v71, v235, v83, v84
  v_cvt_pk_bf16_f32 v233, v66, v67
  v_dot2_f32_bf16 v64, v236, v82, v84
  v_dot2_f32_bf16 v65, v236, v83, v84
  v_cvt_pk_bf16_f32 v234, v68, v69
  v_dot2_f32_bf16 v66, v237, v82, v84
  v_dot2_f32_bf16 v67, v237, v83, v84
  v_cvt_pk_bf16_f32 v235, v70, v71
  v_dot2_f32_bf16 v68, v238, v82, v84
  v_dot2_f32_bf16 v69, v238, v83, v84
  v_cvt_pk_bf16_f32 v236, v64, v65
  v_dot2_f32_bf16 v70, v239, v82, v84
  v_dot2_f32_bf16 v71, v239, v83, v84
  v_cvt_pk_bf16_f32 v237, v66, v67
  v_dot2_f32_bf16 v64, v240, v82, v84
  v_dot2_f32_bf16 v65, v240, v83, v84
  v_cvt_pk_bf16_f32 v238, v68, v69
  v_dot2_f32_bf16 v66, v241, v82, v84
  v_dot2_f32_bf16 v67, v241, v83, v84
  v_cvt_pk_bf16_f32 v239, v70, v71
  v_dot2_f32_bf16 v68, v242, v82, v84
  v_dot2_f32_bf16 v69, v242, v83, v84
  v_cvt_pk_bf16_f32 v240, v64, v65
  v_dot2_f32_bf16 v70, v243, v82, v84
  v_dot2_f32_bf16 v71, v243, v83, v84
  v_cvt_pk_bf16_f32 v241, v66, v67
  ds_read_b32 v7, v72
  v_dot2_f32_bf16 v64, v244, v82, v84
  v_dot2_f32_bf16 v65, v244, v83, v84
  v_cvt_pk_bf16_f32 v242, v68, v69
  v_dot2_f32_bf16 v66, v245, v82, v84
  v_dot2_f32_bf16 v67, v245, v83, v84
  v_cvt_pk_bf16_f32 v243, v70, v71
  v_dot2_f32_bf16 v68, v246, v82, v84
  v_dot2_f32_bf16 v69, v246, v83, v84
  v_cvt_pk_bf16_f32 v244, v64, v65
  v_dot2_f32_bf16 v70, v247, v82, v84
  v_dot2_f32_bf16 v71, v247, v83, v84
  v_cvt_pk_bf16_f32 v245, v66, v67
  v_dot2_f32_bf16 v64, v248, v82, v84
  v_dot2_f32_bf16 v65, v248, v83, v84
  v_cvt_pk_bf16_f32 v246, v68, v69
  v_dot2_f32_bf16 v66, v249, v82, v84
  v_dot2_f32_bf16 v67, v249, v83, v84
  v_cvt_pk_bf16_f32 v247, v70, v71
  v_dot2_f32_bf16 v68, v250, v82, v84
  v_dot2_f32_bf16 v69, v250, v83, v84
  v_cvt_pk_bf16_f32 v248, v64, v65
  v_dot2_f32_bf16 v70, v251, v82, v84
  v_dot2_f32_bf16 v71, v251, v83, v84
  v_cvt_pk_bf16_f32 v249, v66, v67
  s_waitcnt lgkmcnt(0)
  v_cmp_le_u32 vcc, 1, v7
  s_nop 0
  s_cmp_eq_u64 vcc, -1
  s_cbranch_scc0 sig11_slow
sig11_ok:
  ds_read_b64_tr_b16 v[112:113], v10 offset:0
  ds_read_b64_tr_b16 v[114:115], v10 offset:256
  ds_read_b64_tr_b16 v[116:117], v10 offset:1024
  ds_read_b64_tr_b16 v[118:119], v10 offset:1280
  ds_read_b64_tr_b16 v[120:121], v10 offset:2048
  ds_read_b64_tr_b16 v[122:123], v10 offset:2304
  ds_read_b64_tr_b16 v[124:125], v10 offset:3072
  ds_read_b64_tr_b16 v[126:127], v10 offset:3328
.p2align 3
  v_dot2_f32_bf16 v64, v252, v82, v84
  v_dot2_f32_bf16 v65, v252, v83, v84
  v_cvt_pk_bf16_f32 v250, v68, v69
  v_dot2_f32_bf16 v66, v253, v82, v84
  v_dot2_f32_bf16 v67, v253, v83, v84
  v_cvt_pk_bf16_f32 v251, v70, v71
  v_dot2_f32_bf16 v68, v254, v82, v84
  v_dot2_f32_bf16 v69, v254, v83, v84
  v_cvt_pk_bf16_f32 v252, v64, v65
  v_dot2_f32_bf16 v70, v255, v82, v84
  v_dot2_f32_bf16 v71, v255, v83, v84
  v_cvt_pk_bf16_f32 v253, v66, v67
  s_nop 1
  v_cvt_pk_bf16_f32 v254, v68, v69
  v_cvt_pk_bf16_f32 v255, v70, v71
  s_waitcnt lgkmcnt(6)
  v_mfma_f32_32x32x16_bf16 v[48:63], v[112:115], v[128:131], 0
  ds_read_b64_tr_b16 v[112:113], v10 offset:4096
  ds_read_b64_tr_b16 v[114:115], v10 offset:4352
  s_waitcnt lgkmcnt(6)
  v_mfma_f32_32x32x16_bf16 v[48:63], v[116:119], v[132:135], v[48:63]
  ds_read_b64_tr_b16 v[116:117], v10 offset:5120
  ds_read_b64_tr_b16 v[118:119], v10 offset:5376
  s_waitcnt lgkmcnt(6)
  v_mfma_f32_32x32x16_bf16 v[48:63], v[120:123], v[136:139], v[48:63]
  ds_read_b64_tr_b16 v[120:121], v10 offset:6144
  ds_read_b64_tr_b16 v[122:123], v10 offset:6400
  s_waitcnt lgkmcnt(6)
  v_mfma_f32_32x32x16_bf16 v[48:63], v[124:127], v[140:143], v[48:63]
  ds_read_b64_tr_b16 v[124:125], v10 offset:7168
  ds_read_b64_tr_b16 v[126:127], v10 offset:7424
  s_waitcnt lgkmcnt(6)
  v_mfma_f32_32x32x16_bf16 v[48:63], v[112:115], v[144:147], v[48:63]
  ds_read_b64_tr_b16 v[112:113], v10 offset:8192
  ds_read_b64_tr_b16 v[114:115], v10 offset:8448
  s_waitcnt lgkmcnt(6)
  v_mfma_f32_32x32x16_bf16 v[48:63], v[116:119], v[148:151], v[48:63]
  ds_read_b64_tr_b16 v[116:117], v10 offset:9216
  ds_read_b64_tr_b16 v[118:119], v10 offset:9472
  s_waitcnt lgkmcnt(6)
  v_mfma_f32_32x32x16_bf16 v[48:63], v[120:123], v[152:155], v[48:63]
  ds_read_b64_tr_b16 v[120:121], v10 offset:10240
  ds_read_b64_tr_b16 v[122:123], v10 offset:10496
  s_waitcnt lgkmcnt(6)
  v_mfma_f32_32x32x16_bf16 v[48:63], v[124:127], v[156:159], v[48:63]
  ds_read_b64_tr_b16 v[124:125], v10 offset:11264
  ds_read_b64_tr_b16 v[126:127], v10 offset:11520
  s_waitcnt lgkmcnt(6)
  v_mfma_f32_32x32x16_bf16 v[48:63], v[112:115], v[160:163], v[48:63]
  ds_read_b64_tr_b16 v[112:113], v10 offset:12288
  ds_read_b64_tr_b16 v[114:115], v10 offset:12544
  s_waitcnt lgkmcnt(6)
  v_mfma_f32_32x32x16_bf16 v[48:63], v[116:119], v[164:167], v[48:63]
  ds_read_b64_tr_b16 v[116:117], v10 offset:13312
  ds_read_b64_tr_b16 v[118:119], v10 offset:13568
  s_waitcnt lgkmcnt(6)
  v_mfma_f32_32x32x16_bf16 v[48:63], v[120:123], v[168:171], v[48:63]
  ds_read_b64_tr_b16 v[120:121], v10 offset:14336
  ds_read_b64_tr_b16 v[122:123], v10 offset:14592
  s_waitcnt lgkmcnt(6)
  v_mfma_f32_32x32x16_bf16 v[48:63], v[124:127], v[172:175], v[48:63]
  ds_read_b64_tr_b16 v[124:125], v10 offset:15360
  ds_read_b64_tr_b16 v[126:127], v10 offset:15616
  s_waitcnt lgkmcnt(6)
  v_mfma_f32_32x32x16_bf16 v[48:63], v[112:115], v[176:179], v[48:63]
  ds_read_b64_tr_b16 v[112:113], v10 offset:16384
  ds_read_b64_tr_b16 v[114:115], v10 offset:16640
  s_waitcnt lgkmcnt(6)
  v_mfma_f32_32x32x16_bf16 v[48:63], v[116:119], v[180:183], v[48:63]
  ds_read_b64_tr_b16 v[116:117], v10 offset:17408
  ds_read_b64_tr_b16 v[118:119], v10 offset:17664
  s_waitcnt lgkmcnt(6)
  v_mfma_f32_32x32x16_bf16 v[48:63], v[120:123], v[184:187], v[48:63]
  ds_read_b64_tr_b16 v[120:121], v10 offset:18432
  ds_read_b64_tr_b16 v[122:123], v10 offset:18688
  s_waitcnt lgkmcnt(6)
  v_mfma_f32_32x32x16_bf16 v[48:63], v[124:127], v[188:191], v[48:63]
  ds_read_b64_tr_b16 v[124:125], v10 offset:19456
  ds_read_b64_tr_b16 v[126:127], v10 offset:19712
  s_waitcnt lgkmcnt(6)
  v_mfma_f32_32x32x16_bf16 v[48:63], v[112:115], v[192:195], v[48:63]
  ds_read_b64_tr_b16 v[112:113], v10 offset:20480
  ds_read_b64_tr_b16 v[114:115], v10 offset:20736
  s_waitcnt lgkmcnt(6)
  v_mfma_f32_32x32x16_bf16 v[48:63], v[116:119], v[196:199], v[48:63]
  ds_read_b64_tr_b16 v[116:117], v10 offset:21504
  ds_read_b64_tr_b16 v[118:119], v10 offset:21760
  s_waitcnt lgkmcnt(6)
  v_mfma_f32_32x32x16_bf16 v[48:63], v[120:123], v[200:203], v[48:63]
  ds_read_b64_tr_b16 v[120:121], v10 offset:22528
  ds_read_b64_tr_b16 v[122:123], v10 offset:22784
  s_waitcnt lgkmcnt(6)
  v_mfma_f32_32x32x16_bf16 v[48:63], v[124:127], v[204:207], v[48:63]
  ds_read_b64_tr_b16 v[124:125], v10 offset:23552
  ds_read_b64_tr_b16 v[126:127], v10 offset:23808
  s_waitcnt lgkmcnt(6)
  v_mfma_f32_32x32x16_bf16 v[48:63], v[112:115], v[208:211], v[48:63]
  ds_read_b64_tr_b16 v[112:113], v10 offset:24576
  ds_read_b64_tr_b16 v[114:115], v10 offset:24832
  s_waitcnt lgkmcnt(6)
  v_mfma_f32_32x32x16_bf16 v[48:63], v[116:119], v[212:215], v[48:63]
  ds_read_b64_tr_b16 v[116:117], v10 offset:25600
  ds_read_b64_tr_b16 v[118:119], v10 offset:25856
  s_waitcnt lgkmcnt(6)
  v_mfma_f32_32x32x16_bf16 v[48:63], v[120:123], v[216:219], v[48:63]
  ds_read_b64_tr_b16 v[120:121], v10 offset:26624
  ds_read_b64_tr_b16 v[122:123], v10 offset:26880
  s_waitcnt lgkmcnt(6)
  v_mfma_f32_32x32x16_bf16 v[48:63], v[124:127], v[220:223], v[48:63]
  ds_read_b64_tr_b16 v[124:125], v10 offset:27648
  ds_read_b64_tr_b16 v[126:127], v10 offset:27904
  s_waitcnt lgkmcnt(6)
  v_mfma_f32_32x32x16_bf16 v[48:63], v[112:115], v[224:227], v[48:63]
  ds_read_b64_tr_b16 v[112:113], v10 offset:28672
  ds_read_b64_tr_b16 v[114:115], v10 offset:28928
  s_waitcnt lgkmcnt(6)
  v_mfma_f32_32x32x16_bf16 v[48:63], v[116:119], v[228:231], v[48:63]
  ds_read_b64_tr_b16 v[116:117], v10 offset:29696
  ds_read_b64_tr_b16 v[118:119], v10 offset:29952
  s_waitcnt lgkmcnt(6)
  v_mfma_f32_32x32x16_bf16 v[48:63], v[120:123], v[232:235], v[48:63]
  ds_read_b64_tr_b16 v[120:121], v10 offset:30720
  ds_read_b64_tr_b16 v[122:123], v10 offset:30976
  s_waitcnt lgkmcnt(6)
  v_mfma_f32_32x32x16_bf16 v[48:63], v[124:127], v[236:239], v[48:63]
  ds_read_b64_tr_b16 v[124:125], v10 offset:31744
  ds_read_b64_tr_b16 v[126:127], v10 offset:32000
  s_waitcnt lgkmcnt(6)
  v_mfma_f32_32x32x16_bf16 v[48:63], v[112:115], v[240:243], v[48:63]
  s_waitcnt lgkmcnt(4)
  v_mfma_f32_32x32x16_bf16 v[48:63], v[116:119], v[244:247], v[48:63]
  s_waitcnt lgkmcnt(2)
  v_mfma_f32_32x32x16_bf16 v[48:63], v[120:123], v[248:251], v[48:63]
  s_waitcnt lgkmcnt(0)
  v_mfma_f32_32x32x16_bf16 v[48:63], v[124:127], v[252:255], v[48:63]
  s_nop 4
  v_mul_f32 v82, 0x3eb8aa3b, v95
  v_mul_f32 v95, v95, v95
  s_lshl_b32 s3, s52, 10
  s_add_u32 s3, s3, 151552
  v_add_u32 v80, s3, v1
  v_mov_b32 v6, 3
  s_nop 0
  v_mul_f32 v48, v82, v48
  v_mul_f32 v49, v82, v49
  v_mul_f32 v50, v82, v50
  v_mul_f32 v51, v82, v51
  v_mul_f32 v52, v82, v52
  v_mul_f32 v53, v82, v53
  v_mul_f32 v54, v82, v54
  v_mul_f32 v55, v82, v55
  v_mul_f32 v56, v82, v56
  v_mul_f32 v57, v82, v57
  v_mul_f32 v58, v82, v58
  v_mul_f32 v59, v82, v59
  v_mul_f32 v60, v82, v60
  v_mul_f32 v61, v82, v61
  v_mul_f32 v62, v82, v62
  v_mul_f32 v63, v82, v63
  v_cvt_pk_bf16_f32 v48, v48, v49
  v_cvt_pk_bf16_f32 v49, v50, v51
  v_cvt_pk_bf16_f32 v50, v52, v53
  v_cvt_pk_bf16_f32 v51, v54, v55
  v_cvt_pk_bf16_f32 v52, v56, v57
  v_cvt_pk_bf16_f32 v53, v58, v59
  v_cvt_pk_bf16_f32 v54, v60, v61
  v_cvt_pk_bf16_f32 v55, v62, v63
  ds_write_b128 v80, v[48:51]
  ds_write_b128 v80, v[52:55] offset:4096
  s_waitcnt lgkmcnt(0)
  ds_write_b32 v4, v6
PADa_0:
  s_cbranch_execz PADa_4
  v_lshrrev_b32 v76, 3, v0
  v_mul_u32_u24 v76, 3584, v76
  v_bfe_u32 v77, v0, 4, 1
  v_lshlrev_b32 v77, 1, v77
  s_and_b32 s3, s52, 1
  s_lshl_b32 s3, s3, 2
  v_xor_b32 v77, s3, v77
  v_and_b32 v78, 7, v0
  v_xor_b32 v77, v77, v78
  v_lshl_add_u32 v88, v77, 4, v76
  v_add_u32 v89, 27648, v88
  v_add_u32 v90, 55296, v88
  v_add_u32 v91, 82944, v88
  v_add_u32 v76, 0, v0
  v_mul_u32_u24 v77, 43691, v76
  v_lshrrev_b32 v77, 18, v77
  v_mul_u32_u24 v78, 6, v77
  v_sub_u32 v78, v76, v78
  v_mul_u32_u24 v77, 3584, v77
  v_lshl_add_u32 v77, v78, 4, v77
  v_subrev_u32 v92, 0, v77
  v_add_u32 v76, 64, v0
  v_mul_u32_u24 v77, 43691, v76
  v_lshrrev_b32 v77, 18, v77
  v_mul_u32_u24 v78, 6, v77
  v_sub_u32 v78, v76, v78
  v_mul_u32_u24 v77, 3584, v77
  v_lshl_add_u32 v77, v78, 4, v77
  v_subrev_u32 v93, 1024, v77
  v_add_u32 v76, 128, v0
  v_mul_u32_u24 v77, 43691, v76
  v_lshrrev_b32 v77, 18, v77
  v_mul_u32_u24 v78, 6, v77
  v_sub_u32 v78, v76, v78
  v_mul_u32_u24 v77, 3584, v77
  v_lshl_add_u32 v77, v78, 4, v77
  v_subrev_u32 v94, 2048, v77
  v_lshrrev_b32 v76, 5, v0
  v_bfe_u32 v78, v0, 2, 2
  v_lshl_add_u32 v78, v76, 3, v78
  v_bfe_u32 v79, v0, 4, 1
  v_and_b32 v75, 3, v0
  v_mul_u32_u24 v76, 96, v78
  v_mul_u32_u24 v77, 6272, v79
  v_add_u32 v76, v76, v77
  v_lshl_add_u32 v68, v75, 3, v76
  v_lshlrev_b32 v76, 7, v78
  v_lshl_add_u32 v76, v79, 13, v76
  v_lshl_add_u32 v76, v75, 3, v76
  v_bfe_u32 v77, v0, 3, 1
  v_lshl_add_u32 v77, v79, 1, v77
  v_xor_b32 v78, 0, v77
  v_lshl_add_u32 v64, v78, 5, v76
  v_xor_b32 v78, 1, v77
  v_lshl_add_u32 v65, v78, 5, v76
  v_xor_b32 v78, 2, v77
  v_lshl_add_u32 v66, v78, 5, v76
  v_xor_b32 v78, 3, v77
  v_lshl_add_u32 v67, v78, 5, v76
  v_mov_b32 v8, v64
  v_mov_b32 v9, v65
  v_mov_b32 v10, v66
  v_mov_b32 v11, v67
  v_mov_b32 v12, v68
  ds_read_b32 v7, v72
  s_waitcnt lgkmcnt(0)
  v_cmp_le_u32 vcc, 2, v7
  s_nop 0
  s_cmp_eq_u64 vcc, -1
  s_cbranch_scc0 sig12_slow
sig12_ok:
  s_add_u32 s60, s55, 1
  s_and_b32 s60, s60, 7
  s_mul_i32 s60, s60, 229376
  s_add_u32 m0, s71, 81920
  s_add_u32 s60, s60, s63
PADa_1:
  s_cbranch_execz PADa_5
  buffer_load_dwordx4 v88, s[32:35], s60 offen offset:0 lds
  buffer_load_dwordx4 v89, s[32:35], s60 offen offset:1024 lds
  buffer_load_dwordx4 v90, s[32:35], s60 offen offset:2048 lds
  buffer_load_dwordx4 v91, s[32:35], s60 offen offset:3072 lds
  s_setprio 0
  s_mul_i32 s65, s69, 114688
  s_add_u32 s65, s65, 10485760
  s_lshl_b32 s3, s69, 4
  s_add_u32 s3, s3, s54
  s_lshl_b32 s3, s3, 7
  s_add_u32 s66, s3, 6422528
  s_setprio 2
  v_add_u32 v8, 98304, v8
  v_add_u32 v9, 98304, v9
  v_add_u32 v10, 98304, v10
  v_add_u32 v11, 98304, v11
  v_add_u32 v12, 98304, v12
  s_setprio 0
  ds_read_b64_tr_b16 v[96:97], v8 offset:32768
  ds_read_b64_tr_b16 v[98:99], v8 offset:33280
  ds_read_b64_tr_b16 v[100:101], v9 offset:32768
  ds_read_b64_tr_b16 v[102:103], v9 offset:33280
  ds_read_b64_tr_b16 v[104:105], v10 offset:32768
  ds_read_b64_tr_b16 v[106:107], v10 offset:33280
  ds_read_b64_tr_b16 v[108:109], v11 offset:32768
  ds_read_b64_tr_b16 v[110:111], v11 offset:33280
  s_waitcnt lgkmcnt(6)
  v_mfma_f32_32x32x16_bf16 v[16:31], v[96:99], v[128:131], 0
  s_add_u32 s60, s55, 2
  s_and_b32 s60, s60, 7
  s_mul_i32 s60, s60, 229376
  s_add_u32 m0, s71, 0
  s_add_u32 s60, s60, s63
  buffer_load_dwordx4 v88, s[32:35], s60 offen offset:0 lds
  ds_read_b64_tr_b16 v[96:97], v8 offset:34816
  ds_read_b64_tr_b16 v[98:99], v8 offset:35328
  s_waitcnt lgkmcnt(6)
  v_mfma_f32_32x32x16_bf16 v[32:47], v[100:103], v[128:131], 0
  buffer_load_dwordx4 v89, s[32:35], s60 offen offset:1024 lds
  ds_read_b64_tr_b16 v[100:101], v9 offset:34816
  ds_read_b64_tr_b16 v[102:103], v9 offset:35328
  s_waitcnt lgkmcnt(6)
  v_mfma_f32_32x32x16_bf16 v[48:63], v[104:107], v[128:131], 0
  buffer_load_dwordx4 v90, s[32:35], s60 offen offset:2048 lds
  ds_read_b64_tr_b16 v[104:105], v10 offset:34816
  ds_read_b64_tr_b16 v[106:107], v10 offset:35328
  s_waitcnt lgkmcnt(6)
  v_mfma_f32_32x32x16_bf16 v[64:79], v[108:111], v[128:131], 0
  buffer_load_dwordx4 v91, s[32:35], s60 offen offset:3072 lds
  ds_read_b64_tr_b16 v[108:109], v11 offset:34816
  ds_read_b64_tr_b16 v[110:111], v11 offset:35328
  s_waitcnt lgkmcnt(6)
  v_mfma_f32_32x32x16_bf16 v[16:31], v[96:99], v[132:135], v[16:31]
  s_add_u32 s60, s55, 3
  s_and_b32 s60, s60, 7
  s_mul_i32 s60, s60, 229376
  s_add_u32 m0, s71, 16384
  s_add_u32 s60, s60, s63
  buffer_load_dwordx4 v88, s[32:35], s60 offen offset:0 lds
  ds_read_b64_tr_b16 v[96:97], v8 offset:36864
  ds_read_b64_tr_b16 v[98:99], v8 offset:37376
  s_waitcnt lgkmcnt(6)
  v_mfma_f32_32x32x16_bf16 v[32:47], v[100:103], v[132:135], v[32:47]
  buffer_load_dwordx4 v89, s[32:35], s60 offen offset:1024 lds
  ds_read_b64_tr_b16 v[100:101], v9 offset:36864
PADa_2:
  s_cbranch_execz PADa_6
  ds_read_b64_tr_b16 v[102:103], v9 offset:37376
  s_waitcnt lgkmcnt(6)
  v_mfma_f32_32x32x16_bf16 v[48:63], v[104:107], v[132:135], v[48:63]
  buffer_load_dwordx4 v90, s[32:35], s60 offen offset:2048 lds
  s_waitcnt vmcnt(7)
  s_setprio 2
  v_mov_b32 v6, 5
  ds_write_b32 v4, v6
  s_setprio 0
  ds_read_b64_tr_b16 v[104:105], v10 offset:36864
  ds_read_b64_tr_b16 v[106:107], v10 offset:37376
  s_waitcnt lgkmcnt(7)
  v_mfma_f32_32x32x16_bf16 v[64:79], v[108:111], v[132:135], v[64:79]
  buffer_load_dwordx4 v91, s[32:35], s60 offen offset:3072 lds
  ds_read_b64_tr_b16 v[108:109], v11 offset:36864
  ds_read_b64_tr_b16 v[110:111], v11 offset:37376
  s_waitcnt lgkmcnt(7)
  v_mfma_f32_32x32x16_bf16 v[16:31], v[96:99], v[136:139], v[16:31]
  ds_read_b64_tr_b16 v[96:97], v8 offset:38912
  ds_read_b64_tr_b16 v[98:99], v8 offset:39424
  s_waitcnt lgkmcnt(7)
  v_mfma_f32_32x32x16_bf16 v[32:47], v[100:103], v[136:139], v[32:47]
  ds_read_b32 v7, v5
  ds_read_b64_tr_b16 v[100:101], v9 offset:38912
  ds_read_b64_tr_b16 v[102:103], v9 offset:39424
  s_waitcnt lgkmcnt(7)
  v_mfma_f32_32x32x16_bf16 v[48:63], v[104:107], v[136:139], v[48:63]
  ds_read_b64_tr_b16 v[104:105], v10 offset:38912
  ds_read_b64_tr_b16 v[106:107], v10 offset:39424
  s_waitcnt lgkmcnt(7)
  v_mfma_f32_32x32x16_bf16 v[64:79], v[108:111], v[136:139], v[64:79]
  ds_read_b64_tr_b16 v[108:109], v11 offset:38912
  ds_read_b64_tr_b16 v[110:111], v11 offset:39424
  s_waitcnt lgkmcnt(7)
  v_mfma_f32_32x32x16_bf16 v[16:31], v[96:99], v[140:143], v[16:31]
  s_setprio 2
  s_waitcnt lgkmcnt(6)
  v_cmp_le_u32 vcc, 5, v7
  s_nop 0
  s_cmp_eq_u64 vcc, -1
  s_cbranch_scc0 sig13_slow
sig13_ok:
  s_setprio 0
  s_setprio 2
  v_subrev_u32 v8, 49152, v8
  v_subrev_u32 v9, 49152, v9
  v_subrev_u32 v10, 49152, v10
  v_subrev_u32 v11, 49152, v11
  v_subrev_u32 v12, 49152, v12
  s_setprio 0
  ds_read_b64_tr_b16 v[96:97], v8 offset:32768
  ds_read_b64_tr_b16 v[98:99], v8 offset:33280
  s_waitcnt lgkmcnt(6)
  v_mfma_f32_32x32x16_bf16 v[32:47], v[100:103], v[140:143], v[32:47]
  ds_read_b64_tr_b16 v[100:101], v9 offset:32768
  ds_read_b64_tr_b16 v[102:103], v9 offset:33280
  s_waitcnt lgkmcnt(6)
  v_mfma_f32_32x32x16_bf16 v[48:63], v[104:107], v[140:143], v[48:63]
  ds_read_b64_tr_b16 v[104:105], v10 offset:32768
  ds_read_b64_tr_b16 v[106:107], v10 offset:33280
  s_waitcnt lgkmcnt(6)
  v_mfma_f32_32x32x16_bf16 v[64:79], v[108:111], v[140:143], v[64:79]
  ds_read_b64_tr_b16 v[108:109], v11 offset:32768
  ds_read_b64_tr_b16 v[110:111], v11 offset:33280
  s_waitcnt lgkmcnt(6)
  v_mfma_f32_32x32x16_bf16 v[16:31], v[96:99], v[144:147], v[16:31]
  s_add_u32 s60, s55, 4
  s_and_b32 s60, s60, 7
  s_mul_i32 s60, s60, 229376
PADa_3:
  s_cbranch_execz PADa_7
  s_add_u32 m0, s71, 32768
  s_add_u32 s60, s60, s63
  buffer_load_dwordx4 v88, s[32:35], s60 offen offset:0 lds
  ds_read_b64_tr_b16 v[96:97], v8 offset:34816
  ds_read_b64_tr_b16 v[98:99], v8 offset:35328
  s_waitcnt lgkmcnt(6)
  v_mfma_f32_32x32x16_bf16 v[32:47], v[100:103], v[144:147], v[32:47]
  buffer_load_dwordx4 v89, s[32:35], s60 offen offset:1024 lds
  ds_read_b64_tr_b16 v[100:101], v9 offset:34816
  ds_read_b64_tr_b16 v[102:103], v9 offset:35328
  s_waitcnt lgkmcnt(6)
  v_mfma_f32_32x32x16_bf16 v[48:63], v[104:107], v[144:147], v[48:63]
  buffer_load_dwordx4 v90, s[32:35], s60 offen offset:2048 lds
  ds_read_b64_tr_b16 v[104:105], v10 offset:34816
  ds_read_b64_tr_b16 v[106:107], v10 offset:35328
  s_waitcnt lgkmcnt(6)
  v_mfma_f32_32x32x16_bf16 v[64:79], v[108:111], v[144:147], v[64:79]
  buffer_load_dwordx4 v91, s[32:35], s60 offen offset:3072 lds
  ds_read_b64_tr_b16 v[108:109], v11 offset:34816
  ds_read_b64_tr_b16 v[110:111], v11 offset:35328
  s_waitcnt lgkmcnt(6)
  v_mfma_f32_32x32x16_bf16 v[16:31], v[96:99], v[148:151], v[16:31]
  ds_read_b64_tr_b16 v[96:97], v8 offset:36864
  ds_read_b64_tr_b16 v[98:99], v8 offset:37376
  s_waitcnt lgkmcnt(6)
  v_mfma_f32_32x32x16_bf16 v[32:47], v[100:103], v[148:151], v[32:47]
  ds_read_b64_tr_b16 v[100:101], v9 offset:36864
  ds_read_b64_tr_b16 v[102:103], v9 offset:37376
  s_waitcnt lgkmcnt(6)
  v_mfma_f32_32x32x16_bf16 v[48:63], v[104:107], v[148:151], v[48:63]
  s_waitcnt vmcnt(8)
  s_setprio 2
  v_mov_b32 v6, 6
  ds_write_b32 v4, v6
  s_setprio 0
  ds_read_b64_tr_b16 v[104:105], v10 offset:36864
  ds_read_b64_tr_b16 v[106:107], v10 offset:37376
  s_waitcnt lgkmcnt(7)
  v_mfma_f32_32x32x16_bf16 v[64:79], v[108:111], v[148:151], v[64:79]
  ds_read_b64_tr_b16 v[108:109], v11 offset:36864
  ds_read_b64_tr_b16 v[110:111], v11 offset:37376
  s_waitcnt lgkmcnt(7)
  v_mfma_f32_32x32x16_bf16 v[16:31], v[96:99], v[152:155], v[16:31]
  ds_read_b64_tr_b16 v[96:97], v8 offset:38912
  ds_read_b64_tr_b16 v[98:99], v8 offset:39424
  s_waitcnt lgkmcnt(7)
  v_mfma_f32_32x32x16_bf16 v[32:47], v[100:103], v[152:155], v[32:47]
  ds_read_b32 v7, v5
  ds_read_b64_tr_b16 v[100:101], v9 offset:38912
  ds_read_b64_tr_b16 v[102:103], v9 offset:39424
  s_waitcnt lgkmcnt(7)
  v_mfma_f32_32x32x16_bf16 v[48:63], v[104:107], v[152:155], v[48:63]
  ds_read_b64_tr_b16 v[104:105], v10 offset:38912
  ds_read_b64_tr_b16 v[106:107], v10 offset:39424
  s_waitcnt lgkmcnt(7)
  v_mfma_f32_32x32x16_bf16 v[64:79], v[108:111], v[152:155], v[64:79]
  ds_read_b64_tr_b16 v[108:109], v11 offset:38912
  ds_read_b64_tr_b16 v[110:111], v11 offset:39424
  s_waitcnt lgkmcnt(7)
  v_mfma_f32_32x32x16_bf16 v[16:31], v[96:99], v[156:159], v[16:31]
  s_setprio 2
  s_waitcnt lgkmcnt(6)
  v_cmp_le_u32 vcc, 6, v7
  s_nop 0
  s_cmp_eq_u64 vcc, -1
  s_cbranch_scc0 sig14_slow
sig14_ok:
  s_setprio 0
  s_setprio 2
PADa_4:
  s_cbranch_execz PADa_8
  v_subrev_u32 v8, 49152, v8
  v_subrev_u32 v9, 49152, v9
  v_subrev_u32 v10, 49152, v10
  v_subrev_u32 v11, 49152, v11
  v_subrev_u32 v12, 49152, v12
  s_setprio 0
  ds_read_b64_tr_b16 v[96:97], v8 offset:0
  ds_read_b64_tr_b16 v[98:99], v8 offset:512
  s_waitcnt lgkmcnt(6)
  v_mfma_f32_32x32x16_bf16 v[32:47], v[100:103], v[156:159], v[32:47]
  ds_read_b64_tr_b16 v[100:101], v9 offset:0
  ds_read_b64_tr_b16 v[102:103], v9 offset:512
  s_waitcnt lgkmcnt(6)
  v_mfma_f32_32x32x16_bf16 v[48:63], v[104:107], v[156:159], v[48:63]
  ds_read_b64_tr_b16 v[104:105], v10 offset:0
  ds_read_b64_tr_b16 v[106:107], v10 offset:512
  s_waitcnt lgkmcnt(6)
  v_mfma_f32_32x32x16_bf16 v[64:79], v[108:111], v[156:159], v[64:79]
  ds_read_b64_tr_b16 v[108:109], v11 offset:0
  ds_read_b64_tr_b16 v[110:111], v11 offset:512
  s_waitcnt lgkmcnt(6)
  v_mfma_f32_32x32x16_bf16 v[16:31], v[96:99], v[160:163], v[16:31]
  s_add_u32 s60, s55, 5
  s_and_b32 s60, s60, 7
  s_mul_i32 s60, s60, 229376
  s_add_u32 m0, s71, 49152
  s_add_u32 s60, s60, s63
  buffer_load_dwordx4 v88, s[32:35], s60 offen offset:0 lds
  ds_read_b64_tr_b16 v[96:97], v8 offset:2048
  ds_read_b64_tr_b16 v[98:99], v8 offset:2560
  s_waitcnt lgkmcnt(6)
  v_mfma_f32_32x32x16_bf16 v[32:47], v[100:103], v[160:163], v[32:47]
  buffer_load_dwordx4 v89, s[32:35], s60 offen offset:1024 lds
  ds_read_b64_tr_b16 v[100:101], v9 offset:2048
  ds_read_b64_tr_b16 v[102:103], v9 offset:2560
  s_waitcnt lgkmcnt(6)
  v_mfma_f32_32x32x16_bf16 v[48:63], v[104:107], v[160:163], v[48:63]
  buffer_load_dwordx4 v90, s[32:35], s60 offen offset:2048 lds
  ds_read_b64_tr_b16 v[104:105], v10 offset:2048
  ds_read_b64_tr_b16 v[106:107], v10 offset:2560
  s_waitcnt lgkmcnt(6)
  v_mfma_f32_32x32x16_bf16 v[64:79], v[108:111], v[160:163], v[64:79]
  buffer_load_dwordx4 v91, s[32:35], s60 offen offset:3072 lds
  ds_read_b64_tr_b16 v[108:109], v11 offset:2048
  ds_read_b64_tr_b16 v[110:111], v11 offset:2560
  s_waitcnt lgkmcnt(6)
  v_mfma_f32_32x32x16_bf16 v[16:31], v[96:99], v[164:167], v[16:31]
  ds_read_b64_tr_b16 v[96:97], v8 offset:4096
  ds_read_b64_tr_b16 v[98:99], v8 offset:4608
  s_waitcnt lgkmcnt(6)
  v_mfma_f32_32x32x16_bf16 v[32:47], v[100:103], v[164:167], v[32:47]
  ds_read_b64_tr_b16 v[100:101], v9 offset:4096
  ds_read_b64_tr_b16 v[102:103], v9 offset:4608
  s_waitcnt lgkmcnt(6)
  v_mfma_f32_32x32x16_bf16 v[48:63], v[104:107], v[164:167], v[48:63]
  s_waitcnt vmcnt(8)
  s_setprio 2
  v_mov_b32 v6, 7
  ds_write_b32 v4, v6
  s_setprio 0
  ds_read_b64_tr_b16 v[104:105], v10 offset:4096
  ds_read_b64_tr_b16 v[106:107], v10 offset:4608
  s_waitcnt lgkmcnt(7)
  v_mfma_f32_32x32x16_bf16 v[64:79], v[108:111], v[164:167], v[64:79]
  ds_read_b64_tr_b16 v[108:109], v11 offset:4096
PADa_5:
  s_cbranch_execz PADa_9
  ds_read_b64_tr_b16 v[110:111], v11 offset:4608
  s_waitcnt lgkmcnt(7)
  v_mfma_f32_32x32x16_bf16 v[16:31], v[96:99], v[168:171], v[16:31]
  ds_read_b64_tr_b16 v[96:97], v8 offset:6144
  ds_read_b64_tr_b16 v[98:99], v8 offset:6656
  s_waitcnt lgkmcnt(7)
  v_mfma_f32_32x32x16_bf16 v[32:47], v[100:103], v[168:171], v[32:47]
  ds_read_b32 v7, v5
  ds_read_b64_tr_b16 v[100:101], v9 offset:6144
  ds_read_b64_tr_b16 v[102:103], v9 offset:6656
  s_waitcnt lgkmcnt(7)
  v_mfma_f32_32x32x16_bf16 v[48:63], v[104:107], v[168:171], v[48:63]
  ds_read_b64_tr_b16 v[104:105], v10 offset:6144
  ds_read_b64_tr_b16 v[106:107], v10 offset:6656
  s_waitcnt lgkmcnt(7)
  v_mfma_f32_32x32x16_bf16 v[64:79], v[108:111], v[168:171], v[64:79]
  ds_read_b64_tr_b16 v[108:109], v11 offset:6144
  ds_read_b64_tr_b16 v[110:111], v11 offset:6656
  s_waitcnt lgkmcnt(7)
  v_mfma_f32_32x32x16_bf16 v[16:31], v[96:99], v[172:175], v[16:31]
  s_setprio 2
  s_waitcnt lgkmcnt(6)
  v_cmp_le_u32 vcc, 7, v7
  s_nop 0
  s_cmp_eq_u64 vcc, -1
  s_cbranch_scc0 sig15_slow
sig15_ok:
  s_setprio 0
  ds_read_b64_tr_b16 v[96:97], v8 offset:16384
  ds_read_b64_tr_b16 v[98:99], v8 offset:16896
  s_waitcnt lgkmcnt(6)
  v_mfma_f32_32x32x16_bf16 v[32:47], v[100:103], v[172:175], v[32:47]
  ds_read_b64_tr_b16 v[100:101], v9 offset:16384
  ds_read_b64_tr_b16 v[102:103], v9 offset:16896
  s_waitcnt lgkmcnt(6)
  v_mfma_f32_32x32x16_bf16 v[48:63], v[104:107], v[172:175], v[48:63]
  ds_read_b64_tr_b16 v[104:105], v10 offset:16384
  ds_read_b64_tr_b16 v[106:107], v10 offset:16896
  s_waitcnt lgkmcnt(6)
  v_mfma_f32_32x32x16_bf16 v[64:79], v[108:111], v[172:175], v[64:79]
  ds_read_b64_tr_b16 v[108:109], v11 offset:16384
  ds_read_b64_tr_b16 v[110:111], v11 offset:16896
  s_waitcnt lgkmcnt(6)
  v_mfma_f32_32x32x16_bf16 v[16:31], v[96:99], v[176:179], v[16:31]
  s_add_u32 s60, s55, 6
  s_and_b32 s60, s60, 7
  s_mul_i32 s60, s60, 229376
  s_add_u32 m0, s71, 65536
  s_add_u32 s60, s60, s63
  buffer_load_dwordx4 v88, s[32:35], s60 offen offset:0 lds
  ds_read_b64_tr_b16 v[96:97], v8 offset:18432
  ds_read_b64_tr_b16 v[98:99], v8 offset:18944
  s_waitcnt lgkmcnt(6)
  v_mfma_f32_32x32x16_bf16 v[32:47], v[100:103], v[176:179], v[32:47]
  buffer_load_dwordx4 v89, s[32:35], s60 offen offset:1024 lds
  ds_read_b64_tr_b16 v[100:101], v9 offset:18432
  ds_read_b64_tr_b16 v[102:103], v9 offset:18944
  s_waitcnt lgkmcnt(6)
  v_mfma_f32_32x32x16_bf16 v[48:63], v[104:107], v[176:179], v[48:63]
  buffer_load_dwordx4 v90, s[32:35], s60 offen offset:2048 lds
  ds_read_b64_tr_b16 v[104:105], v10 offset:18432
  ds_read_b64_tr_b16 v[106:107], v10 offset:18944
  s_waitcnt lgkmcnt(6)
  v_mfma_f32_32x32x16_bf16 v[64:79], v[108:111], v[176:179], v[64:79]
  buffer_load_dwordx4 v91, s[32:35], s60 offen offset:3072 lds
  ds_read_b64_tr_b16 v[108:109], v11 offset:18432
  ds_read_b64_tr_b16 v[110:111], v11 offset:18944
  s_waitcnt lgkmcnt(6)
PADa_6:
  s_cbranch_execz PADa_10
  v_mfma_f32_32x32x16_bf16 v[16:31], v[96:99], v[180:183], v[16:31]
  ds_read_b64_tr_b16 v[96:97], v8 offset:20480
  ds_read_b64_tr_b16 v[98:99], v8 offset:20992
  s_waitcnt lgkmcnt(6)
  v_mfma_f32_32x32x16_bf16 v[32:47], v[100:103], v[180:183], v[32:47]
  ds_read_b64_tr_b16 v[100:101], v9 offset:20480
  ds_read_b64_tr_b16 v[102:103], v9 offset:20992
  s_waitcnt lgkmcnt(6)
  v_mfma_f32_32x32x16_bf16 v[48:63], v[104:107], v[180:183], v[48:63]
  s_waitcnt vmcnt(8)
  s_setprio 2
  v_mov_b32 v6, 8
  ds_write_b32 v4, v6
  s_setprio 0
  ds_read_b64_tr_b16 v[104:105], v10 offset:20480
  ds_read_b64_tr_b16 v[106:107], v10 offset:20992
  s_waitcnt lgkmcnt(7)
  v_mfma_f32_32x32x16_bf16 v[64:79], v[108:111], v[180:183], v[64:79]
  ds_read_b64_tr_b16 v[108:109], v11 offset:20480
  ds_read_b64_tr_b16 v[110:111], v11 offset:20992
  s_waitcnt lgkmcnt(7)
  v_mfma_f32_32x32x16_bf16 v[16:31], v[96:99], v[184:187], v[16:31]
  ds_read_b64_tr_b16 v[96:97], v8 offset:22528
  ds_read_b64_tr_b16 v[98:99], v8 offset:23040
  s_waitcnt lgkmcnt(7)
  v_mfma_f32_32x32x16_bf16 v[32:47], v[100:103], v[184:187], v[32:47]
  ds_read_b32 v7, v5
  ds_read_b64_tr_b16 v[100:101], v9 offset:22528
  ds_read_b64_tr_b16 v[102:103], v9 offset:23040
  s_waitcnt lgkmcnt(7)
  v_mfma_f32_32x32x16_bf16 v[48:63], v[104:107], v[184:187], v[48:63]
  ds_read_b64_tr_b16 v[104:105], v10 offset:22528
  ds_read_b64_tr_b16 v[106:107], v10 offset:23040
  s_waitcnt lgkmcnt(7)
  v_mfma_f32_32x32x16_bf16 v[64:79], v[108:111], v[184:187], v[64:79]
  ds_read_b64_tr_b16 v[108:109], v11 offset:22528
  ds_read_b64_tr_b16 v[110:111], v11 offset:23040
  s_waitcnt lgkmcnt(7)
  v_mfma_f32_32x32x16_bf16 v[16:31], v[96:99], v[188:191], v[16:31]
  s_setprio 2
  s_waitcnt lgkmcnt(6)
  v_cmp_le_u32 vcc, 8, v7
  s_nop 0
  s_cmp_eq_u64 vcc, -1
  s_cbranch_scc0 sig16_slow
sig16_ok:
  s_setprio 0
  ds_read_b64_tr_b16 v[96:97], v8 offset:32768
  ds_read_b64_tr_b16 v[98:99], v8 offset:33280
  s_waitcnt lgkmcnt(6)
  v_mfma_f32_32x32x16_bf16 v[32:47], v[100:103], v[188:191], v[32:47]
  ds_read_b64_tr_b16 v[100:101], v9 offset:32768
  ds_read_b64_tr_b16 v[102:103], v9 offset:33280
  s_waitcnt lgkmcnt(6)
  v_mfma_f32_32x32x16_bf16 v[48:63], v[104:107], v[188:191], v[48:63]
  ds_read_b64_tr_b16 v[104:105], v10 offset:32768
  ds_read_b64_tr_b16 v[106:107], v10 offset:33280
  s_waitcnt lgkmcnt(6)
  v_mfma_f32_32x32x16_bf16 v[64:79], v[108:111], v[188:191], v[64:79]
  ds_read_b64_tr_b16 v[108:109], v11 offset:32768
  ds_read_b64_tr_b16 v[110:111], v11 offset:33280
  s_waitcnt lgkmcnt(6)
  v_mfma_f32_32x32x16_bf16 v[16:31], v[96:99], v[192:195], v[16:31]
  s_add_u32 s60, s55, 7
  s_and_b32 s60, s60, 7
  s_mul_i32 s60, s60, 229376
  s_add_u32 m0, s71, 81920
  s_add_u32 s60, s60, s63
  buffer_load_dwordx4 v88, s[32:35], s60 offen offset:0 lds
PADa_7:
  s_cbranch_execz PADa_11
  ds_read_b64_tr_b16 v[96:97], v8 offset:34816
  ds_read_b64_tr_b16 v[98:99], v8 offset:35328
  s_waitcnt lgkmcnt(6)
  v_mfma_f32_32x32x16_bf16 v[32:47], v[100:103], v[192:195], v[32:47]
  buffer_load_dwordx4 v89, s[32:35], s60 offen offset:1024 lds
  ds_read_b64_tr_b16 v[100:101], v9 offset:34816
  ds_read_b64_tr_b16 v[102:103], v9 offset:35328
  s_waitcnt lgkmcnt(6)
  v_mfma_f32_32x32x16_bf16 v[48:63], v[104:107], v[192:195], v[48:63]
  buffer_load_dwordx4 v90, s[32:35], s60 offen offset:2048 lds
  ds_read_b64_tr_b16 v[104:105], v10 offset:34816
  ds_read_b64_tr_b16 v[106:107], v10 offset:35328
  s_waitcnt lgkmcnt(6)
  v_mfma_f32_32x32x16_bf16 v[64:79], v[108:111], v[192:195], v[64:79]
  buffer_load_dwordx4 v91, s[32:35], s60 offen offset:3072 lds
  ds_read_b64_tr_b16 v[108:109], v11 offset:34816
  ds_read_b64_tr_b16 v[110:111], v11 offset:35328
  s_waitcnt lgkmcnt(6)
  v_mfma_f32_32x32x16_bf16 v[16:31], v[96:99], v[196:199], v[16:31]
  ds_read_b64_tr_b16 v[96:97], v8 offset:36864
  ds_read_b64_tr_b16 v[98:99], v8 offset:37376
  s_waitcnt lgkmcnt(6)
  v_mfma_f32_32x32x16_bf16 v[32:47], v[100:103], v[196:199], v[32:47]
  ds_read_b64_tr_b16 v[100:101], v9 offset:36864
  ds_read_b64_tr_b16 v[102:103], v9 offset:37376
  s_waitcnt lgkmcnt(6)
  v_mfma_f32_32x32x16_bf16 v[48:63], v[104:107], v[196:199], v[48:63]
  s_waitcnt vmcnt(8)
  s_setprio 2
  v_mov_b32 v6, 9
  ds_write_b32 v4, v6
  s_setprio 0
  ds_read_b64_tr_b16 v[104:105], v10 offset:36864
  ds_read_b64_tr_b16 v[106:107], v10 offset:37376
  s_waitcnt lgkmcnt(7)
  v_mfma_f32_32x32x16_bf16 v[64:79], v[108:111], v[196:199], v[64:79]
  ds_read_b64_tr_b16 v[108:109], v11 offset:36864
  ds_read_b64_tr_b16 v[110:111], v11 offset:37376
  s_waitcnt lgkmcnt(7)
  v_mfma_f32_32x32x16_bf16 v[16:31], v[96:99], v[200:203], v[16:31]
  ds_read_b64_tr_b16 v[96:97], v8 offset:38912
  ds_read_b64_tr_b16 v[98:99], v8 offset:39424
  s_waitcnt lgkmcnt(7)
  v_mfma_f32_32x32x16_bf16 v[32:47], v[100:103], v[200:203], v[32:47]
  ds_read_b32 v7, v5
  ds_read_b64_tr_b16 v[100:101], v9 offset:38912
  ds_read_b64_tr_b16 v[102:103], v9 offset:39424
  s_waitcnt lgkmcnt(7)
  v_mfma_f32_32x32x16_bf16 v[48:63], v[104:107], v[200:203], v[48:63]
  ds_read_b64_tr_b16 v[104:105], v10 offset:38912
  ds_read_b64_tr_b16 v[106:107], v10 offset:39424
  s_waitcnt lgkmcnt(7)
  v_mfma_f32_32x32x16_bf16 v[64:79], v[108:111], v[200:203], v[64:79]
  ds_read_b64_tr_b16 v[108:109], v11 offset:38912
  ds_read_b64_tr_b16 v[110:111], v11 offset:39424
  s_waitcnt lgkmcnt(7)
  v_mfma_f32_32x32x16_bf16 v[16:31], v[96:99], v[204:207], v[16:31]
  s_setprio 2
  s_waitcnt lgkmcnt(6)
  v_cmp_le_u32 vcc, 9, v7
  s_nop 0
  s_cmp_eq_u64 vcc, -1
  s_cbranch_scc0 sig17_slow
sig17_ok:
  s_setprio 0
  s_setprio 2
  v_add_u32 v8, 49152, v8
  v_add_u32 v9, 49152, v9
PADa_8:
  s_cbranch_execz PADa_12
  v_add_u32 v10, 49152, v10
  v_add_u32 v11, 49152, v11
  v_add_u32 v12, 49152, v12
  s_setprio 0
  ds_read_b64_tr_b16 v[96:97], v8 offset:0
  ds_read_b64_tr_b16 v[98:99], v8 offset:512
  s_waitcnt lgkmcnt(6)
  v_mfma_f32_32x32x16_bf16 v[32:47], v[100:103], v[204:207], v[32:47]
  ds_read_b64_tr_b16 v[100:101], v9 offset:0
  ds_read_b64_tr_b16 v[102:103], v9 offset:512
  s_waitcnt lgkmcnt(6)
  v_mfma_f32_32x32x16_bf16 v[48:63], v[104:107], v[204:207], v[48:63]
  ds_read_b64_tr_b16 v[104:105], v10 offset:0
  ds_read_b64_tr_b16 v[106:107], v10 offset:512
  s_waitcnt lgkmcnt(6)
  v_mfma_f32_32x32x16_bf16 v[64:79], v[108:111], v[204:207], v[64:79]
  ds_read_b64_tr_b16 v[108:109], v11 offset:0
  ds_read_b64_tr_b16 v[110:111], v11 offset:512
  s_waitcnt lgkmcnt(6)
  v_mfma_f32_32x32x16_bf16 v[16:31], v[96:99], v[208:211], v[16:31]
  s_add_u32 s60, s55, 0
  s_and_b32 s60, s60, 7
  s_mul_i32 s60, s60, 229376
  s_add_u32 m0, s61, 0
  s_add_u32 s60, s60, s64
  buffer_load_dwordx4 v92, s[32:35], s60 offen offset:0 lds
  ds_read_b64_tr_b16 v[96:97], v8 offset:2048
  ds_read_b64_tr_b16 v[98:99], v8 offset:2560
  s_waitcnt lgkmcnt(6)
  v_mfma_f32_32x32x16_bf16 v[32:47], v[100:103], v[208:211], v[32:47]
  buffer_load_dwordx4 v93, s[32:35], s60 offen offset:1024 lds
  ds_read_b64_tr_b16 v[100:101], v9 offset:2048
  ds_read_b64_tr_b16 v[102:103], v9 offset:2560
  s_waitcnt lgkmcnt(6)
  v_mfma_f32_32x32x16_bf16 v[48:63], v[104:107], v[208:211], v[48:63]
  buffer_load_dwordx4 v94, s[32:35], s60 offen offset:2048 lds
  ds_read_b64_tr_b16 v[104:105], v10 offset:2048
  ds_read_b64_tr_b16 v[106:107], v10 offset:2560
  s_waitcnt lgkmcnt(6)
  v_mfma_f32_32x32x16_bf16 v[64:79], v[108:111], v[208:211], v[64:79]
  ds_read_b64_tr_b16 v[108:109], v11 offset:2048
  ds_read_b64_tr_b16 v[110:111], v11 offset:2560
  s_waitcnt lgkmcnt(6)
  v_mfma_f32_32x32x16_bf16 v[16:31], v[96:99], v[212:215], v[16:31]
  ds_read_b64_tr_b16 v[96:97], v8 offset:4096
  ds_read_b64_tr_b16 v[98:99], v8 offset:4608
  s_waitcnt lgkmcnt(6)
  v_mfma_f32_32x32x16_bf16 v[32:47], v[100:103], v[212:215], v[32:47]
  ds_read_b64_tr_b16 v[100:101], v9 offset:4096
  ds_read_b64_tr_b16 v[102:103], v9 offset:4608
  s_waitcnt lgkmcnt(6)
  v_mfma_f32_32x32x16_bf16 v[48:63], v[104:107], v[212:215], v[48:63]
  s_waitcnt vmcnt(7)
  s_setprio 2
  v_mov_b32 v6, 10
  ds_write_b32 v4, v6
  s_setprio 0
  ds_read_b64_tr_b16 v[104:105], v10 offset:4096
  ds_read_b64_tr_b16 v[106:107], v10 offset:4608
  s_waitcnt lgkmcnt(7)
  v_mfma_f32_32x32x16_bf16 v[64:79], v[108:111], v[212:215], v[64:79]
  ds_read_b64_tr_b16 v[108:109], v11 offset:4096
  ds_read_b64_tr_b16 v[110:111], v11 offset:4608
  s_waitcnt lgkmcnt(7)
  v_mfma_f32_32x32x16_bf16 v[16:31], v[96:99], v[216:219], v[16:31]
  ds_read_b64_tr_b16 v[96:97], v8 offset:6144
PADa_9:
  s_cbranch_execz PADa_13
  ds_read_b64_tr_b16 v[98:99], v8 offset:6656
  s_waitcnt lgkmcnt(7)
  v_mfma_f32_32x32x16_bf16 v[32:47], v[100:103], v[216:219], v[32:47]
  ds_read_b32 v7, v5
  ds_read_b64_tr_b16 v[100:101], v9 offset:6144
  ds_read_b64_tr_b16 v[102:103], v9 offset:6656
  s_waitcnt lgkmcnt(7)
  v_mfma_f32_32x32x16_bf16 v[48:63], v[104:107], v[216:219], v[48:63]
  ds_read_b64_tr_b16 v[104:105], v10 offset:6144
  ds_read_b64_tr_b16 v[106:107], v10 offset:6656
  s_waitcnt lgkmcnt(7)
  v_mfma_f32_32x32x16_bf16 v[64:79], v[108:111], v[216:219], v[64:79]
  ds_read_b64_tr_b16 v[108:109], v11 offset:6144
  ds_read_b64_tr_b16 v[110:111], v11 offset:6656
  s_waitcnt lgkmcnt(7)
  v_mfma_f32_32x32x16_bf16 v[16:31], v[96:99], v[220:223], v[16:31]
  s_setprio 2
  s_waitcnt lgkmcnt(6)
  v_cmp_le_u32 vcc, 10, v7
  s_nop 0
  s_cmp_eq_u64 vcc, -1
  s_cbranch_scc0 sig18_slow
sig18_ok:
  s_setprio 0
  ds_read_b64_tr_b16 v[96:97], v8 offset:16384
  ds_read_b64_tr_b16 v[98:99], v8 offset:16896
  s_waitcnt lgkmcnt(6)
  v_mfma_f32_32x32x16_bf16 v[32:47], v[100:103], v[220:223], v[32:47]
  ds_read_b64_tr_b16 v[100:101], v9 offset:16384
  ds_read_b64_tr_b16 v[102:103], v9 offset:16896
  s_waitcnt lgkmcnt(6)
  v_mfma_f32_32x32x16_bf16 v[48:63], v[104:107], v[220:223], v[48:63]
  ds_read_b64_tr_b16 v[104:105], v10 offset:16384
  ds_read_b64_tr_b16 v[106:107], v10 offset:16896
  s_waitcnt lgkmcnt(6)
  v_mfma_f32_32x32x16_bf16 v[64:79], v[108:111], v[220:223], v[64:79]
  ds_read_b64_tr_b16 v[108:109], v11 offset:16384
  ds_read_b64_tr_b16 v[110:111], v11 offset:16896
  s_waitcnt lgkmcnt(6)
  v_mfma_f32_32x32x16_bf16 v[16:31], v[96:99], v[224:227], v[16:31]
  s_add_u32 s60, s55, 1
  s_and_b32 s60, s60, 7
  s_mul_i32 s60, s60, 229376
  s_add_u32 m0, s61, 12416
  s_add_u32 s60, s60, s64
  buffer_load_dwordx4 v92, s[32:35], s60 offen offset:0 lds
  ds_read_b64_tr_b16 v[96:97], v8 offset:18432
  ds_read_b64_tr_b16 v[98:99], v8 offset:18944
  s_waitcnt lgkmcnt(6)
  v_mfma_f32_32x32x16_bf16 v[32:47], v[100:103], v[224:227], v[32:47]
  buffer_load_dwordx4 v93, s[32:35], s60 offen offset:1024 lds
  ds_read_b64_tr_b16 v[100:101], v9 offset:18432
  ds_read_b64_tr_b16 v[102:103], v9 offset:18944
  s_waitcnt lgkmcnt(6)
  v_mfma_f32_32x32x16_bf16 v[48:63], v[104:107], v[224:227], v[48:63]
  buffer_load_dwordx4 v94, s[32:35], s60 offen offset:2048 lds
  ds_read_b64_tr_b16 v[104:105], v10 offset:18432
  ds_read_b64_tr_b16 v[106:107], v10 offset:18944
  s_waitcnt lgkmcnt(6)
  v_mfma_f32_32x32x16_bf16 v[64:79], v[108:111], v[224:227], v[64:79]
  ds_read_b64_tr_b16 v[108:109], v11 offset:18432
  ds_read_b64_tr_b16 v[110:111], v11 offset:18944
  s_waitcnt lgkmcnt(6)
  v_mfma_f32_32x32x16_bf16 v[16:31], v[96:99], v[228:231], v[16:31]
  ds_read_b64_tr_b16 v[96:97], v8 offset:20480
  ds_read_b64_tr_b16 v[98:99], v8 offset:20992
  s_waitcnt lgkmcnt(6)
  v_mfma_f32_32x32x16_bf16 v[32:47], v[100:103], v[228:231], v[32:47]
PADa_10:
  s_cbranch_execz PADa_14
  ds_read_b64_tr_b16 v[100:101], v9 offset:20480
  ds_read_b64_tr_b16 v[102:103], v9 offset:20992
  s_waitcnt lgkmcnt(6)
  v_mfma_f32_32x32x16_bf16 v[48:63], v[104:107], v[228:231], v[48:63]
  s_waitcnt vmcnt(6)
  s_setprio 2
  v_mov_b32 v6, 11
  ds_write_b32 v4, v6
  s_setprio 0
  ds_read_b64_tr_b16 v[104:105], v10 offset:20480
  ds_read_b64_tr_b16 v[106:107], v10 offset:20992
  s_waitcnt lgkmcnt(7)
  v_mfma_f32_32x32x16_bf16 v[64:79], v[108:111], v[228:231], v[64:79]
  ds_read_b64_tr_b16 v[108:109], v11 offset:20480
  ds_read_b64_tr_b16 v[110:111], v11 offset:20992
  s_waitcnt lgkmcnt(7)
  v_mfma_f32_32x32x16_bf16 v[16:31], v[96:99], v[232:235], v[16:31]
  ds_read_b64_tr_b16 v[96:97], v8 offset:22528
  ds_read_b64_tr_b16 v[98:99], v8 offset:23040
  s_waitcnt lgkmcnt(7)
  v_mfma_f32_32x32x16_bf16 v[32:47], v[100:103], v[232:235], v[32:47]
  ds_read_b32 v7, v5
  ds_read_b64_tr_b16 v[100:101], v9 offset:22528
  ds_read_b64_tr_b16 v[102:103], v9 offset:23040
  s_waitcnt lgkmcnt(7)
  v_mfma_f32_32x32x16_bf16 v[48:63], v[104:107], v[232:235], v[48:63]
  ds_read_b64_tr_b16 v[104:105], v10 offset:22528
  ds_read_b64_tr_b16 v[106:107], v10 offset:23040
  s_waitcnt lgkmcnt(7)
  v_mfma_f32_32x32x16_bf16 v[64:79], v[108:111], v[232:235], v[64:79]
  ds_read_b64_tr_b16 v[108:109], v11 offset:22528
  ds_read_b64_tr_b16 v[110:111], v11 offset:23040
  s_waitcnt lgkmcnt(7)
  v_mfma_f32_32x32x16_bf16 v[16:31], v[96:99], v[236:239], v[16:31]
  s_setprio 2
  s_waitcnt lgkmcnt(6)
  v_cmp_le_u32 vcc, 11, v7
  s_nop 0
  s_cmp_eq_u64 vcc, -1
  s_cbranch_scc0 sig19_slow
sig19_ok:
  s_setprio 0
  ds_read_b64_tr_b16 v[96:97], v8 offset:32768
  ds_read_b64_tr_b16 v[98:99], v8 offset:33280
  s_waitcnt lgkmcnt(6)
  v_mfma_f32_32x32x16_bf16 v[32:47], v[100:103], v[236:239], v[32:47]
  ds_read_b64_tr_b16 v[100:101], v9 offset:32768
  ds_read_b64_tr_b16 v[102:103], v9 offset:33280
  s_waitcnt lgkmcnt(6)
  v_mfma_f32_32x32x16_bf16 v[48:63], v[104:107], v[236:239], v[48:63]
  ds_read_b64_tr_b16 v[104:105], v10 offset:32768
  ds_read_b64_tr_b16 v[106:107], v10 offset:33280
  s_waitcnt lgkmcnt(6)
  v_mfma_f32_32x32x16_bf16 v[64:79], v[108:111], v[236:239], v[64:79]
  ds_read_b64_tr_b16 v[108:109], v11 offset:32768
  ds_read_b64_tr_b16 v[110:111], v11 offset:33280
  s_waitcnt lgkmcnt(6)
  v_mfma_f32_32x32x16_bf16 v[16:31], v[96:99], v[240:243], v[16:31]
  s_add_u32 s60, s55, 2
  s_and_b32 s60, s60, 7
  s_mul_i32 s60, s60, 229376
  s_add_u32 m0, s61, 24832
  s_add_u32 s60, s60, s64
  buffer_load_dwordx4 v92, s[32:35], s60 offen offset:0 lds
  ds_read_b64_tr_b16 v[96:97], v8 offset:34816
  ds_read_b64_tr_b16 v[98:99], v8 offset:35328
  s_waitcnt lgkmcnt(6)
  v_mfma_f32_32x32x16_bf16 v[32:47], v[100:103], v[240:243], v[32:47]
  buffer_load_dwordx4 v93, s[32:35], s60 offen offset:1024 lds
PADa_11:
  s_cbranch_execz PADa_15
  ds_read_b64_tr_b16 v[100:101], v9 offset:34816
  ds_read_b64_tr_b16 v[102:103], v9 offset:35328
  s_waitcnt lgkmcnt(6)
  v_mfma_f32_32x32x16_bf16 v[48:63], v[104:107], v[240:243], v[48:63]
  buffer_load_dwordx4 v94, s[32:35], s60 offen offset:2048 lds
  ds_read_b64_tr_b16 v[104:105], v10 offset:34816
  ds_read_b64_tr_b16 v[106:107], v10 offset:35328
  s_waitcnt lgkmcnt(6)
  v_mfma_f32_32x32x16_bf16 v[64:79], v[108:111], v[240:243], v[64:79]
  ds_read_b64_tr_b16 v[108:109], v11 offset:34816
  ds_read_b64_tr_b16 v[110:111], v11 offset:35328
  s_waitcnt lgkmcnt(6)
  v_mfma_f32_32x32x16_bf16 v[16:31], v[96:99], v[244:247], v[16:31]
  ds_read_b64_tr_b16 v[96:97], v8 offset:36864
  ds_read_b64_tr_b16 v[98:99], v8 offset:37376
  s_waitcnt lgkmcnt(6)
  v_mfma_f32_32x32x16_bf16 v[32:47], v[100:103], v[244:247], v[32:47]
  ds_read_b64_tr_b16 v[100:101], v9 offset:36864
  ds_read_b64_tr_b16 v[102:103], v9 offset:37376
  s_waitcnt lgkmcnt(6)
  v_mfma_f32_32x32x16_bf16 v[48:63], v[104:107], v[244:247], v[48:63]
  s_waitcnt vmcnt(6)
  s_setprio 2
  v_mov_b32 v6, 12
  ds_write_b32 v4, v6
  s_setprio 0
  ds_read_b64_tr_b16 v[104:105], v10 offset:36864
  ds_read_b64_tr_b16 v[106:107], v10 offset:37376
  s_waitcnt lgkmcnt(7)
  v_mfma_f32_32x32x16_bf16 v[64:79], v[108:111], v[244:247], v[64:79]
  ds_read_b64_tr_b16 v[108:109], v11 offset:36864
  ds_read_b64_tr_b16 v[110:111], v11 offset:37376
  s_waitcnt lgkmcnt(7)
  v_mfma_f32_32x32x16_bf16 v[16:31], v[96:99], v[248:251], v[16:31]
  ds_read_b64_tr_b16 v[96:97], v8 offset:38912
  ds_read_b64_tr_b16 v[98:99], v8 offset:39424
  s_waitcnt lgkmcnt(7)
  v_mfma_f32_32x32x16_bf16 v[32:47], v[100:103], v[248:251], v[32:47]
  ds_read_b32 v7, v5
  ds_read_b64_tr_b16 v[100:101], v9 offset:38912
  ds_read_b64_tr_b16 v[102:103], v9 offset:39424
  s_waitcnt lgkmcnt(7)
  v_mfma_f32_32x32x16_bf16 v[48:63], v[104:107], v[248:251], v[48:63]
  ds_read_b64_tr_b16 v[104:105], v10 offset:38912
  ds_read_b64_tr_b16 v[106:107], v10 offset:39424
  s_waitcnt lgkmcnt(7)
  v_mfma_f32_32x32x16_bf16 v[64:79], v[108:111], v[248:251], v[64:79]
  ds_read_b64_tr_b16 v[108:109], v11 offset:38912
  ds_read_b64_tr_b16 v[110:111], v11 offset:39424
  s_waitcnt lgkmcnt(7)
  v_mfma_f32_32x32x16_bf16 v[16:31], v[96:99], v[252:255], v[16:31]
  s_setprio 2
  s_waitcnt lgkmcnt(6)
  v_cmp_le_u32 vcc, 12, v7
  s_nop 0
  s_cmp_eq_u64 vcc, -1
  s_cbranch_scc0 sig20_slow
sig20_ok:
  s_setprio 0
  s_setprio 2
  v_subrev_u32 v8, 49152, v8
  v_subrev_u32 v9, 49152, v9
  v_subrev_u32 v10, 49152, v10
  v_subrev_u32 v11, 49152, v11
  v_subrev_u32 v12, 49152, v12
  s_setprio 0
  ds_read_b64_tr_b16 v[96:97], v12 offset:0
  ds_read_b64_tr_b16 v[98:99], v12 offset:384
  s_waitcnt lgkmcnt(6)
PADa_12:
  s_cbranch_execz PADa_16
  v_mfma_f32_32x32x16_bf16 v[32:47], v[100:103], v[252:255], v[32:47]
  ds_read_b64_tr_b16 v[100:101], v12 offset:32
  ds_read_b64_tr_b16 v[102:103], v12 offset:416
  s_waitcnt lgkmcnt(6)
  v_mfma_f32_32x32x16_bf16 v[48:63], v[104:107], v[252:255], v[48:63]
  ds_read_b64_tr_b16 v[104:105], v12 offset:64
  ds_read_b64_tr_b16 v[106:107], v12 offset:448
  s_waitcnt lgkmcnt(6)
  v_mfma_f32_32x32x16_bf16 v[64:79], v[108:111], v[252:255], v[64:79]
PADa_13:
  s_cbranch_execz PADa_17
  s_setprio 2
  s_lshl_b32 s3, s54, 12
  s_add_u32 s57, s3, s65
  s_nop 4
  v_max_f32 v16, 0, v16
  v_max_f32 v17, 0, v17
  v_max_f32 v18, 0, v18
  v_max_f32 v19, 0, v19
  v_max_f32 v20, 0, v20
  v_max_f32 v21, 0, v21
  v_max_f32 v22, 0, v22
  v_max_f32 v23, 0, v23
  v_mul_f32 v16, v16, v24
  v_mul_f32 v17, v17, v25
  v_mul_f32 v18, v18, v26
  v_mul_f32 v19, v19, v27
  v_mul_f32 v20, v20, v28
  v_mul_f32 v21, v21, v29
  v_mul_f32 v22, v22, v30
  v_mul_f32 v23, v23, v31
  v_mul_f32 v16, v16, v95
  v_mul_f32 v17, v17, v95
  v_mul_f32 v18, v18, v95
  v_mul_f32 v19, v19, v95
  v_mul_f32 v20, v20, v95
  v_mul_f32 v21, v21, v95
  v_mul_f32 v22, v22, v95
  v_mul_f32 v23, v23, v95
  v_cvt_pk_bf16_f32 v112, v16, v17
  v_cvt_pk_bf16_f32 v113, v18, v19
  v_cvt_pk_bf16_f32 v114, v20, v21
  v_cvt_pk_bf16_f32 v115, v22, v23
  buffer_store_dwordx4 v[112:115], v1, s[36:39], s57 offen offset:0 sc1
  v_max_f32 v32, 0, v32
  v_max_f32 v33, 0, v33
  v_max_f32 v34, 0, v34
  v_max_f32 v35, 0, v35
  v_max_f32 v36, 0, v36
  v_max_f32 v37, 0, v37
  v_max_f32 v38, 0, v38
  v_max_f32 v39, 0, v39
  v_mul_f32 v32, v32, v40
  v_mul_f32 v33, v33, v41
  v_mul_f32 v34, v34, v42
  v_mul_f32 v35, v35, v43
  v_mul_f32 v36, v36, v44
  v_mul_f32 v37, v37, v45
  v_mul_f32 v38, v38, v46
  v_mul_f32 v39, v39, v47
  v_mul_f32 v32, v32, v95
  v_mul_f32 v33, v33, v95
  v_mul_f32 v34, v34, v95
  v_mul_f32 v35, v35, v95
  v_mul_f32 v36, v36, v95
  v_mul_f32 v37, v37, v95
  v_mul_f32 v38, v38, v95
  v_mul_f32 v39, v39, v95
  v_cvt_pk_bf16_f32 v116, v32, v33
  v_cvt_pk_bf16_f32 v117, v34, v35
  v_cvt_pk_bf16_f32 v118, v36, v37
  v_cvt_pk_bf16_f32 v119, v38, v39
  buffer_store_dwordx4 v[116:119], v1, s[36:39], s57 offen offset:1024 sc1
  v_max_f32 v48, 0, v48
  v_max_f32 v49, 0, v49
  v_max_f32 v50, 0, v50
  v_max_f32 v51, 0, v51
  v_max_f32 v52, 0, v52
  v_max_f32 v53, 0, v53
  v_max_f32 v54, 0, v54
  v_max_f32 v55, 0, v55
  v_mul_f32 v48, v48, v56
  v_mul_f32 v49, v49, v57
  v_mul_f32 v50, v50, v58
  v_mul_f32 v51, v51, v59
  v_mul_f32 v52, v52, v60
  v_mul_f32 v53, v53, v61
  v_mul_f32 v54, v54, v62
  v_mul_f32 v55, v55, v63
  v_mul_f32 v48, v48, v95
  v_mul_f32 v49, v49, v95
  v_mul_f32 v50, v50, v95
  v_mul_f32 v51, v51, v95
  v_mul_f32 v52, v52, v95
  v_mul_f32 v53, v53, v95
  v_mul_f32 v54, v54, v95
  v_mul_f32 v55, v55, v95
  v_cvt_pk_bf16_f32 v120, v48, v49
  v_cvt_pk_bf16_f32 v121, v50, v51
  v_cvt_pk_bf16_f32 v122, v52, v53
  v_cvt_pk_bf16_f32 v123, v54, v55
  buffer_store_dwordx4 v[120:123], v1, s[36:39], s57 offen offset:2048 sc1
  v_max_f32 v64, 0, v64
  v_max_f32 v65, 0, v65
  v_max_f32 v66, 0, v66
  v_max_f32 v67, 0, v67
  v_max_f32 v68, 0, v68
PADa_14:
  s_cbranch_execz PADa_18
  v_max_f32 v69, 0, v69
  v_max_f32 v70, 0, v70
  v_max_f32 v71, 0, v71
  v_mul_f32 v64, v64, v72
  v_mul_f32 v65, v65, v73
  v_mul_f32 v66, v66, v74
  v_mul_f32 v67, v67, v75
  v_mul_f32 v68, v68, v76
  v_mul_f32 v69, v69, v77
  v_mul_f32 v70, v70, v78
  v_mul_f32 v71, v71, v79
  v_mul_f32 v64, v64, v95
  v_mul_f32 v65, v65, v95
  v_mul_f32 v66, v66, v95
  v_mul_f32 v67, v67, v95
  v_mul_f32 v68, v68, v95
  v_mul_f32 v69, v69, v95
  v_mul_f32 v70, v70, v95
  v_mul_f32 v71, v71, v95
  v_cvt_pk_bf16_f32 v124, v64, v65
  v_cvt_pk_bf16_f32 v125, v66, v67
  v_cvt_pk_bf16_f32 v126, v68, v69
  v_cvt_pk_bf16_f32 v127, v70, v71
  buffer_store_dwordx4 v[124:127], v1, s[36:39], s57 offen offset:3072 sc1
  s_setprio 0
  s_setprio 2
  s_mov_b32 s28, s4
  s_mov_b32 s29, s5
  s_mov_b32 s30, 2097152
  s_mov_b32 s31, 0x20000
  s_mul_i32 s56, s52, 16384
  s_add_u32 s56, s56, 65536
  s_lshr_b32 s25, s54, 1
  s_and_b32 s3, s25, 3
  s_and_b32 s68, s53, 3
  s_add_u32 s68, s68, s3
  s_lshl_b32 s68, s68, 1
  s_and_b32 s3, s54, 1
  s_add_u32 s68, s68, s3
  s_and_b32 s68, s68, 7
  s_mul_i32 s27, s68, 3
  s_lshr_b32 s27, s27, 1
  s_and_b32 s27, s27, 14
  s_lshl_b32 s68, s68, 1
  s_and_b32 s68, s68, 14
  s_lshl_b32 s25, s25, 7
  s_lshl_b32 s62, s53, 2
  s_lshl_b32 s3, s3, 1
  s_add_u32 s62, s62, s3
  v_lshrrev_b32 v64, 3, v0
  v_lshlrev_b32 v64, 10, v64
  v_bfe_u32 v65, v0, 4, 1
  v_lshlrev_b32 v65, 2, v65
  v_and_b32 v66, 7, v0
  v_xor_b32 v65, v65, v66
  v_lshl_add_u32 v2, v65, 4, v64
  v_add_u32 v3, 7168, v2
  s_lshl_b32 s24, s52, 17
  s_add_u32 s24, s24, s25
  s_and_b32 s3, s52, 1
  s_add_u32 s3, s3, s62
  s_lshl_b32 s3, s3, 15
  s_add_u32 s3, s3, s25
  s_lshr_b32 s57, s52, 1
  s_lshl_b32 s57, s57, 6
  s_add_u32 s3, s3, s57
  v_and_b32 v64, 31, v0
  v_lshl_add_u32 v64, v64, 10, s3
  v_lshrrev_b32 v65, 5, v0
  v_lshl_add_u32 v85, v65, 3, v64
  v_lshl_add_u32 v13, v65, 4, v64
  v_and_b32 v66, 1, v0
  v_lshlrev_b32 v67, 11, v66
  v_bfe_u32 v68, v0, 1, 2
  v_lshl_add_u32 v84, v68, 7, v67
  s_lshl_b32 s3, s62, 11
  s_lshl_b32 s58, s52, 9
  s_add_u32 s3, s3, s58
  s_add_u32 s58, s3, 6422528
  v_bfe_u32 v67, v0, 2, 2
  v_lshl_add_u32 v67, v65, 2, v67
  v_lshlrev_b32 v67, 7, v67
  v_lshl_add_u32 v67, v66, 3, v67
  v_bfe_u32 v68, v0, 1, 1
  v_bfe_u32 v64, v0, 4, 1
  v_lshl_add_u32 v68, v64, 1, v68
PADa_15:
  s_cbranch_execz PADa_19
  v_bfe_u32 v64, v0, 3, 1
  s_lshr_b32 s3, s52, 1
  v_xor_b32 v64, s3, v64
  v_lshl_add_u32 v68, v64, 2, v68
  v_lshl_add_u32 v67, v68, 4, v67
  v_add_u32 v82, s56, v67
  v_xor_b32 v67, 64, v67
  v_add_u32 v83, s56, v67
  s_and_b32 s3, s52, 1
  s_mul_i32 s3, s3, 114688
  v_add_u32 v80, s3, v1
  s_sub_u32 s3, 114688, s3
  v_add_u32 v81, s3, v1
  s_mul_i32 s59, s62, 114688
  s_add_u32 s59, s59, 10485760
  s_setprio 0
  ds_read_b64_tr_b16 v[108:109], v12 offset:1536
  ds_read_b64_tr_b16 v[110:111], v12 offset:1920
  s_waitcnt lgkmcnt(6)
  v_mfma_f32_32x32x16_bf16 v[16:31], v[96:99], v[128:131], 0
  s_add_u32 s60, s55, 3
  s_and_b32 s60, s60, 7
  s_mul_i32 s60, s60, 229376
  s_add_u32 m0, s61, 37248
  s_add_u32 s60, s60, s64
  buffer_load_dwordx4 v92, s[32:35], s60 offen offset:0 lds
  ds_read_b64_tr_b16 v[96:97], v12 offset:1568
  ds_read_b64_tr_b16 v[98:99], v12 offset:1952
  s_waitcnt lgkmcnt(6)
  v_mfma_f32_32x32x16_bf16 v[32:47], v[100:103], v[128:131], 0
  buffer_load_dwordx4 v93, s[32:35], s60 offen offset:1024 lds
  ds_read_b64_tr_b16 v[100:101], v12 offset:1600
  ds_read_b64_tr_b16 v[102:103], v12 offset:1984
  s_waitcnt lgkmcnt(6)
  v_mfma_f32_32x32x16_bf16 v[48:63], v[104:107], v[128:131], 0
  buffer_load_dwordx4 v94, s[32:35], s60 offen offset:2048 lds
  s_waitcnt vmcnt(10)
  s_setprio 2
  v_mov_b32 v6, 13
  ds_write_b32 v4, v6
  s_setprio 0
  ds_read_b64_tr_b16 v[104:105], v12 offset:3072
  ds_read_b64_tr_b16 v[106:107], v12 offset:3456
  s_waitcnt lgkmcnt(7)
  v_mfma_f32_32x32x16_bf16 v[16:31], v[108:111], v[132:135], v[16:31]
  ds_read_b64_tr_b16 v[108:109], v12 offset:3104
  ds_read_b64_tr_b16 v[110:111], v12 offset:3488
  s_waitcnt lgkmcnt(7)
  v_mfma_f32_32x32x16_bf16 v[32:47], v[96:99], v[132:135], v[32:47]
  ds_read_b64_tr_b16 v[96:97], v12 offset:3136
  ds_read_b64_tr_b16 v[98:99], v12 offset:3520
  s_waitcnt lgkmcnt(7)
  v_mfma_f32_32x32x16_bf16 v[48:63], v[100:103], v[132:135], v[48:63]
  ds_read_b32 v7, v5
  ds_read_b64_tr_b16 v[100:101], v12 offset:4608
  ds_read_b64_tr_b16 v[102:103], v12 offset:4992
  s_waitcnt lgkmcnt(7)
  v_mfma_f32_32x32x16_bf16 v[16:31], v[104:107], v[136:139], v[16:31]
  ds_read_b64_tr_b16 v[104:105], v12 offset:4640
  ds_read_b64_tr_b16 v[106:107], v12 offset:5024
  s_waitcnt lgkmcnt(7)
  v_mfma_f32_32x32x16_bf16 v[32:47], v[108:111], v[136:139], v[32:47]
  ds_read_b64_tr_b16 v[108:109], v12 offset:4672
  ds_read_b64_tr_b16 v[110:111], v12 offset:5056
  s_waitcnt lgkmcnt(7)
  v_mfma_f32_32x32x16_bf16 v[48:63], v[96:99], v[136:139], v[48:63]
  s_setprio 2
  s_waitcnt lgkmcnt(6)
  v_cmp_le_u32 vcc, 13, v7
  s_nop 0
PADa_16:
  s_cbranch_execz PADa_20
  s_cmp_eq_u64 vcc, -1
  s_cbranch_scc0 sig21_slow
sig21_ok:
  s_setprio 0
  ds_read_b64_tr_b16 v[96:97], v12 offset:12416
  ds_read_b64_tr_b16 v[98:99], v12 offset:12800
  s_waitcnt lgkmcnt(6)
  v_mfma_f32_32x32x16_bf16 v[16:31], v[100:103], v[140:143], v[16:31]
  ds_read_b64_tr_b16 v[100:101], v12 offset:12448
  ds_read_b64_tr_b16 v[102:103], v12 offset:12832
  s_waitcnt lgkmcnt(6)
  v_mfma_f32_32x32x16_bf16 v[32:47], v[104:107], v[140:143], v[32:47]
  ds_read_b64_tr_b16 v[104:105], v12 offset:12480
  ds_read_b64_tr_b16 v[106:107], v12 offset:12864
  s_waitcnt lgkmcnt(6)
  v_mfma_f32_32x32x16_bf16 v[48:63], v[108:111], v[140:143], v[48:63]
  ds_read_b64_tr_b16 v[108:109], v12 offset:13952
  ds_read_b64_tr_b16 v[110:111], v12 offset:14336
  s_waitcnt lgkmcnt(6)
  v_mfma_f32_32x32x16_bf16 v[16:31], v[96:99], v[144:147], v[16:31]
  s_add_u32 s60, s55, 4
  s_and_b32 s60, s60, 7
  s_mul_i32 s60, s60, 229376
  s_add_u32 m0, s61, 49664
  s_add_u32 s60, s60, s64
  buffer_load_dwordx4 v92, s[32:35], s60 offen offset:0 lds
  ds_read_b64_tr_b16 v[96:97], v12 offset:13984
  ds_read_b64_tr_b16 v[98:99], v12 offset:14368
  s_waitcnt lgkmcnt(6)
  v_mfma_f32_32x32x16_bf16 v[32:47], v[100:103], v[144:147], v[32:47]
  buffer_load_dwordx4 v93, s[32:35], s60 offen offset:1024 lds
  ds_read_b64_tr_b16 v[100:101], v12 offset:14016
  ds_read_b64_tr_b16 v[102:103], v12 offset:14400
  s_waitcnt lgkmcnt(6)
  v_mfma_f32_32x32x16_bf16 v[48:63], v[104:107], v[144:147], v[48:63]
  buffer_load_dwordx4 v94, s[32:35], s60 offen offset:2048 lds
  s_waitcnt vmcnt(10)
  s_setprio 2
  v_mov_b32 v6, 14
  ds_write_b32 v4, v6
  s_setprio 0
  ds_read_b64_tr_b16 v[104:105], v12 offset:15488
  ds_read_b64_tr_b16 v[106:107], v12 offset:15872
  s_waitcnt lgkmcnt(7)
  v_mfma_f32_32x32x16_bf16 v[16:31], v[108:111], v[148:151], v[16:31]
  ds_read_b64_tr_b16 v[108:109], v12 offset:15520
  ds_read_b64_tr_b16 v[110:111], v12 offset:15904
  s_waitcnt lgkmcnt(7)
  v_mfma_f32_32x32x16_bf16 v[32:47], v[96:99], v[148:151], v[32:47]
  ds_read_b64_tr_b16 v[96:97], v12 offset:15552
  ds_read_b64_tr_b16 v[98:99], v12 offset:15936
  s_waitcnt lgkmcnt(7)
  v_mfma_f32_32x32x16_bf16 v[48:63], v[100:103], v[148:151], v[48:63]
  ds_read_b32 v7, v5
  ds_read_b64_tr_b16 v[100:101], v12 offset:17024
  ds_read_b64_tr_b16 v[102:103], v12 offset:17408
  s_waitcnt lgkmcnt(7)
  v_mfma_f32_32x32x16_bf16 v[16:31], v[104:107], v[152:155], v[16:31]
  ds_read_b64_tr_b16 v[104:105], v12 offset:17056
  ds_read_b64_tr_b16 v[106:107], v12 offset:17440
  s_waitcnt lgkmcnt(7)
  v_mfma_f32_32x32x16_bf16 v[32:47], v[108:111], v[152:155], v[32:47]
  ds_read_b64_tr_b16 v[108:109], v12 offset:17088
  ds_read_b64_tr_b16 v[110:111], v12 offset:17472
  s_waitcnt lgkmcnt(7)
  v_mfma_f32_32x32x16_bf16 v[48:63], v[96:99], v[152:155], v[48:63]
  s_setprio 2
  s_waitcnt lgkmcnt(6)
  v_cmp_le_u32 vcc, 14, v7
PADa_17:
  s_cbranch_execz PADa_21
  s_nop 0
  s_cmp_eq_u64 vcc, -1
  s_cbranch_scc0 sig22_slow
sig22_ok:
  s_setprio 0
  ds_read_b64_tr_b16 v[96:97], v12 offset:24832
  ds_read_b64_tr_b16 v[98:99], v12 offset:25216
  s_waitcnt lgkmcnt(6)
  v_mfma_f32_32x32x16_bf16 v[16:31], v[100:103], v[156:159], v[16:31]
  ds_read_b64_tr_b16 v[100:101], v12 offset:24864
  ds_read_b64_tr_b16 v[102:103], v12 offset:25248
  s_waitcnt lgkmcnt(6)
  v_mfma_f32_32x32x16_bf16 v[32:47], v[104:107], v[156:159], v[32:47]
  ds_read_b64_tr_b16 v[104:105], v12 offset:24896
  ds_read_b64_tr_b16 v[106:107], v12 offset:25280
  s_waitcnt lgkmcnt(6)
  v_mfma_f32_32x32x16_bf16 v[48:63], v[108:111], v[156:159], v[48:63]
  s_waitcnt vmcnt(6)
  s_setprio 2
  v_mov_b32 v64, 0
  s_mov_b64 exec, 1
  buffer_store_dwordx2 v[14:15], v64, s[36:39], s66 offen sc1
  s_mov_b64 exec, -1
  s_setprio 0
  ds_read_b64_tr_b16 v[108:109], v12 offset:26368
  ds_read_b64_tr_b16 v[110:111], v12 offset:26752
  s_waitcnt lgkmcnt(6)
  v_mfma_f32_32x32x16_bf16 v[16:31], v[96:99], v[160:163], v[16:31]
  s_add_u32 s60, s55, 5
  s_and_b32 s60, s60, 7
  s_mul_i32 s60, s60, 229376
  s_add_u32 m0, s61, 0
  s_add_u32 s60, s60, s64
  buffer_load_dwordx4 v92, s[32:35], s60 offen offset:0 lds
  ds_read_b64_tr_b16 v[96:97], v12 offset:26400
  ds_read_b64_tr_b16 v[98:99], v12 offset:26784
  s_waitcnt lgkmcnt(6)
  v_mfma_f32_32x32x16_bf16 v[32:47], v[100:103], v[160:163], v[32:47]
  buffer_load_dwordx4 v93, s[32:35], s60 offen offset:1024 lds
  ds_read_b64_tr_b16 v[100:101], v12 offset:26432
  ds_read_b64_tr_b16 v[102:103], v12 offset:26816
  s_waitcnt lgkmcnt(6)
  v_mfma_f32_32x32x16_bf16 v[48:63], v[104:107], v[160:163], v[48:63]
  buffer_load_dwordx4 v94, s[32:35], s60 offen offset:2048 lds
  s_waitcnt vmcnt(7)
  s_setprio 2
  v_mov_b32 v6, 15
  ds_write_b32 v4, v6
  s_setprio 0
  ds_read_b64_tr_b16 v[104:105], v12 offset:27904
  ds_read_b64_tr_b16 v[106:107], v12 offset:28288
  s_waitcnt lgkmcnt(7)
  v_mfma_f32_32x32x16_bf16 v[16:31], v[108:111], v[164:167], v[16:31]
  ds_read_b64_tr_b16 v[108:109], v12 offset:27936
  ds_read_b64_tr_b16 v[110:111], v12 offset:28320
  s_waitcnt lgkmcnt(7)
  v_mfma_f32_32x32x16_bf16 v[32:47], v[96:99], v[164:167], v[32:47]
  ds_read_b64_tr_b16 v[96:97], v12 offset:27968
  ds_read_b64_tr_b16 v[98:99], v12 offset:28352
  s_waitcnt lgkmcnt(7)
  v_mfma_f32_32x32x16_bf16 v[48:63], v[100:103], v[164:167], v[48:63]
  ds_read_b32 v7, v5
  ds_read_b64_tr_b16 v[100:101], v12 offset:29440
  ds_read_b64_tr_b16 v[102:103], v12 offset:29824
  s_waitcnt lgkmcnt(7)
  v_mfma_f32_32x32x16_bf16 v[16:31], v[104:107], v[168:171], v[16:31]
  ds_read_b64_tr_b16 v[104:105], v12 offset:29472
  ds_read_b64_tr_b16 v[106:107], v12 offset:29856
  s_waitcnt lgkmcnt(7)
  v_mfma_f32_32x32x16_bf16 v[32:47], v[108:111], v[168:171], v[32:47]
  ds_read_b64_tr_b16 v[108:109], v12 offset:29504
PADa_18:
  s_cbranch_execz PADa_22
  ds_read_b64_tr_b16 v[110:111], v12 offset:29888
  s_waitcnt lgkmcnt(7)
  v_mfma_f32_32x32x16_bf16 v[48:63], v[96:99], v[168:171], v[48:63]
  s_setprio 2
  s_waitcnt lgkmcnt(6)
  v_cmp_le_u32 vcc, 15, v7
  s_nop 0
  s_cmp_eq_u64 vcc, -1
  s_cbranch_scc0 sig23_slow
sig23_ok:
  s_setprio 0
  ds_read_b64_tr_b16 v[96:97], v12 offset:37248
  ds_read_b64_tr_b16 v[98:99], v12 offset:37632
  s_waitcnt lgkmcnt(6)
  v_mfma_f32_32x32x16_bf16 v[16:31], v[100:103], v[172:175], v[16:31]
  ds_read_b64_tr_b16 v[100:101], v12 offset:37280
  ds_read_b64_tr_b16 v[102:103], v12 offset:37664
  s_waitcnt lgkmcnt(6)
  v_mfma_f32_32x32x16_bf16 v[32:47], v[104:107], v[172:175], v[32:47]
  ds_read_b64_tr_b16 v[104:105], v12 offset:37312
  ds_read_b64_tr_b16 v[106:107], v12 offset:37696
  s_waitcnt lgkmcnt(6)
  v_mfma_f32_32x32x16_bf16 v[48:63], v[108:111], v[172:175], v[48:63]
  ds_read_b64_tr_b16 v[108:109], v12 offset:38784
  ds_read_b64_tr_b16 v[110:111], v12 offset:39168
  s_waitcnt lgkmcnt(6)
  v_mfma_f32_32x32x16_bf16 v[16:31], v[96:99], v[176:179], v[16:31]
  s_add_u32 s60, s55, 6
  s_and_b32 s60, s60, 7
  s_mul_i32 s60, s60, 229376
  s_add_u32 m0, s61, 12416
  s_add_u32 s60, s60, s64
  buffer_load_dwordx4 v92, s[32:35], s60 offen offset:0 lds
  ds_read_b64_tr_b16 v[96:97], v12 offset:38816
  ds_read_b64_tr_b16 v[98:99], v12 offset:39200
  s_waitcnt lgkmcnt(6)
  v_mfma_f32_32x32x16_bf16 v[32:47], v[100:103], v[176:179], v[32:47]
  buffer_load_dwordx4 v93, s[32:35], s60 offen offset:1024 lds
  ds_read_b64_tr_b16 v[100:101], v12 offset:38848
  ds_read_b64_tr_b16 v[102:103], v12 offset:39232
  s_waitcnt lgkmcnt(6)
  v_mfma_f32_32x32x16_bf16 v[48:63], v[104:107], v[176:179], v[48:63]
  buffer_load_dwordx4 v94, s[32:35], s60 offen offset:2048 lds
  s_waitcnt vmcnt(7)
  s_setprio 2
  v_mov_b32 v6, 16
  ds_write_b32 v4, v6
  s_setprio 0
  ds_read_b64_tr_b16 v[104:105], v12 offset:40320
  ds_read_b64_tr_b16 v[106:107], v12 offset:40704
  s_waitcnt lgkmcnt(7)
  v_mfma_f32_32x32x16_bf16 v[16:31], v[108:111], v[180:183], v[16:31]
  ds_read_b64_tr_b16 v[108:109], v12 offset:40352
  ds_read_b64_tr_b16 v[110:111], v12 offset:40736
  s_waitcnt lgkmcnt(7)
  v_mfma_f32_32x32x16_bf16 v[32:47], v[96:99], v[180:183], v[32:47]
  ds_read_b64_tr_b16 v[96:97], v12 offset:40384
  ds_read_b64_tr_b16 v[98:99], v12 offset:40768
  s_waitcnt lgkmcnt(7)
  v_mfma_f32_32x32x16_bf16 v[48:63], v[100:103], v[180:183], v[48:63]
  ds_read_b32 v7, v5
  ds_read_b64_tr_b16 v[100:101], v12 offset:41856
  ds_read_b64_tr_b16 v[102:103], v12 offset:42240
  s_waitcnt lgkmcnt(7)
  v_mfma_f32_32x32x16_bf16 v[16:31], v[104:107], v[184:187], v[16:31]
  ds_read_b64_tr_b16 v[104:105], v12 offset:41888
  ds_read_b64_tr_b16 v[106:107], v12 offset:42272
  s_waitcnt lgkmcnt(7)
  v_mfma_f32_32x32x16_bf16 v[32:47], v[108:111], v[184:187], v[32:47]
PADa_19:
  s_cbranch_execz PADa_23
  ds_read_b64_tr_b16 v[108:109], v12 offset:41920
  ds_read_b64_tr_b16 v[110:111], v12 offset:42304
  s_waitcnt lgkmcnt(7)
  v_mfma_f32_32x32x16_bf16 v[48:63], v[96:99], v[184:187], v[48:63]
  s_setprio 2
  s_waitcnt lgkmcnt(6)
  v_cmp_le_u32 vcc, 16, v7
  s_nop 0
  s_cmp_eq_u64 vcc, -1
  s_cbranch_scc0 sig24_slow
sig24_ok:
  s_setprio 0
  s_setprio 2
  v_add_u32 v8, 49152, v8
  v_add_u32 v9, 49152, v9
  v_add_u32 v10, 49152, v10
  v_add_u32 v11, 49152, v11
  v_add_u32 v12, 49152, v12
  s_setprio 0
  ds_read_b64_tr_b16 v[96:97], v12 offset:512
  ds_read_b64_tr_b16 v[98:99], v12 offset:896
  s_waitcnt lgkmcnt(6)
  v_mfma_f32_32x32x16_bf16 v[16:31], v[100:103], v[188:191], v[16:31]
  ds_read_b64_tr_b16 v[100:101], v12 offset:544
  ds_read_b64_tr_b16 v[102:103], v12 offset:928
  s_waitcnt lgkmcnt(6)
  v_mfma_f32_32x32x16_bf16 v[32:47], v[104:107], v[188:191], v[32:47]
  ds_read_b64_tr_b16 v[104:105], v12 offset:576
  ds_read_b64_tr_b16 v[106:107], v12 offset:960
  s_waitcnt lgkmcnt(6)
  v_mfma_f32_32x32x16_bf16 v[48:63], v[108:111], v[188:191], v[48:63]
  ds_read_b64_tr_b16 v[108:109], v12 offset:2048
  ds_read_b64_tr_b16 v[110:111], v12 offset:2432
  s_waitcnt lgkmcnt(6)
  v_mfma_f32_32x32x16_bf16 v[16:31], v[96:99], v[192:195], v[16:31]
  s_add_u32 s60, s55, 7
  s_and_b32 s60, s60, 7
  s_mul_i32 s60, s60, 229376
  s_add_u32 m0, s61, 24832
  s_add_u32 s60, s60, s64
  buffer_load_dwordx4 v92, s[32:35], s60 offen offset:0 lds
  ds_read_b64_tr_b16 v[96:97], v12 offset:2080
  ds_read_b64_tr_b16 v[98:99], v12 offset:2464
  s_waitcnt lgkmcnt(6)
  v_mfma_f32_32x32x16_bf16 v[32:47], v[100:103], v[192:195], v[32:47]
  buffer_load_dwordx4 v93, s[32:35], s60 offen offset:1024 lds
  ds_read_b64_tr_b16 v[100:101], v12 offset:2112
  ds_read_b64_tr_b16 v[102:103], v12 offset:2496
  s_waitcnt lgkmcnt(6)
  v_mfma_f32_32x32x16_bf16 v[48:63], v[104:107], v[192:195], v[48:63]
  buffer_load_dwordx4 v94, s[32:35], s60 offen offset:2048 lds
  s_waitcnt vmcnt(6)
  s_setprio 2
  v_mov_b32 v6, 17
  ds_write_b32 v4, v6
  s_setprio 0
  ds_read_b64_tr_b16 v[104:105], v12 offset:3584
  ds_read_b64_tr_b16 v[106:107], v12 offset:3968
  s_waitcnt lgkmcnt(7)
  v_mfma_f32_32x32x16_bf16 v[16:31], v[108:111], v[196:199], v[16:31]
  ds_read_b64_tr_b16 v[108:109], v12 offset:3616
  ds_read_b64_tr_b16 v[110:111], v12 offset:4000
  s_waitcnt lgkmcnt(7)
  v_mfma_f32_32x32x16_bf16 v[32:47], v[96:99], v[196:199], v[32:47]
  ds_read_b64_tr_b16 v[96:97], v12 offset:3648
  ds_read_b64_tr_b16 v[98:99], v12 offset:4032
  s_waitcnt lgkmcnt(7)
  v_mfma_f32_32x32x16_bf16 v[48:63], v[100:103], v[196:199], v[48:63]
  ds_read_b32 v7, v5
PADa_20:
  s_cbranch_execz PADa_24
  buffer_load_dwordx2 v[64:65], v85, s[28:31], 0 offen offset:0
  buffer_load_dwordx2 v[66:67], v85, s[28:31], 0 offen offset:16
  buffer_load_dwordx2 v[68:69], v85, s[28:31], 0 offen offset:32
  buffer_load_dwordx2 v[70:71], v85, s[28:31], 0 offen offset:48
  buffer_load_dwordx2 v[86:87], v84, s[36:39], s58 offen sc1
  ds_read_b64_tr_b16 v[100:101], v12 offset:5120
  ds_read_b64_tr_b16 v[102:103], v12 offset:5504
  s_waitcnt lgkmcnt(7)
  v_mfma_f32_32x32x16_bf16 v[16:31], v[104:107], v[200:203], v[16:31]
  ds_read_b64_tr_b16 v[104:105], v12 offset:5152
  ds_read_b64_tr_b16 v[106:107], v12 offset:5536
  s_waitcnt lgkmcnt(7)
  v_mfma_f32_32x32x16_bf16 v[32:47], v[108:111], v[200:203], v[32:47]
  ds_read_b64_tr_b16 v[108:109], v12 offset:5184
  ds_read_b64_tr_b16 v[110:111], v12 offset:5568
  s_waitcnt lgkmcnt(7)
  v_mfma_f32_32x32x16_bf16 v[48:63], v[96:99], v[200:203], v[48:63]
  s_setprio 2
  s_waitcnt lgkmcnt(6)
  v_cmp_le_u32 vcc, 17, v7
  s_nop 0
  s_cmp_eq_u64 vcc, -1
  s_cbranch_scc0 sig25_slow
sig25_ok:
  s_setprio 0
  s_setprio 2
  v_subrev_u32 v8, 49152, v8
  v_subrev_u32 v9, 49152, v9
  v_subrev_u32 v10, 49152, v10
  v_subrev_u32 v11, 49152, v11
  v_subrev_u32 v12, 49152, v12
  s_setprio 0
  ds_read_b64_tr_b16 v[96:97], v12 offset:0
  ds_read_b64_tr_b16 v[98:99], v12 offset:384
  s_waitcnt lgkmcnt(6)
  v_mfma_f32_32x32x16_bf16 v[16:31], v[100:103], v[204:207], v[16:31]
  ds_read_b64_tr_b16 v[100:101], v12 offset:32
  ds_read_b64_tr_b16 v[102:103], v12 offset:416
  s_waitcnt lgkmcnt(6)
  v_mfma_f32_32x32x16_bf16 v[32:47], v[104:107], v[204:207], v[32:47]
  ds_read_b64_tr_b16 v[104:105], v12 offset:64
  ds_read_b64_tr_b16 v[106:107], v12 offset:448
  s_waitcnt lgkmcnt(6)
  v_mfma_f32_32x32x16_bf16 v[48:63], v[108:111], v[204:207], v[48:63]
  ds_read_b64_tr_b16 v[108:109], v12 offset:1536
  ds_read_b64_tr_b16 v[110:111], v12 offset:1920
  s_waitcnt lgkmcnt(6)
  v_mfma_f32_32x32x16_bf16 v[16:31], v[96:99], v[208:211], v[16:31]
  ds_read_b64_tr_b16 v[96:97], v12 offset:1568
  ds_read_b64_tr_b16 v[98:99], v12 offset:1952
  s_waitcnt lgkmcnt(6)
  v_mfma_f32_32x32x16_bf16 v[32:47], v[100:103], v[208:211], v[32:47]
  ds_read_b64_tr_b16 v[100:101], v12 offset:1600
  ds_read_b64_tr_b16 v[102:103], v12 offset:1984
  s_waitcnt lgkmcnt(6)
  v_mfma_f32_32x32x16_bf16 v[48:63], v[104:107], v[208:211], v[48:63]
  s_waitcnt vmcnt(8)
  s_setprio 2
  v_mov_b32 v6, 18
  ds_write_b32 v4, v6
  s_setprio 0
  ds_read_b64_tr_b16 v[104:105], v12 offset:3072
  ds_read_b64_tr_b16 v[106:107], v12 offset:3456
  s_waitcnt lgkmcnt(7)
  v_mfma_f32_32x32x16_bf16 v[16:31], v[108:111], v[212:215], v[16:31]
  ds_read_b64_tr_b16 v[108:109], v12 offset:3104
  ds_read_b64_tr_b16 v[110:111], v12 offset:3488
  s_waitcnt lgkmcnt(7)
PADa_21:
  s_cbranch_execz PADa_25
  v_mfma_f32_32x32x16_bf16 v[32:47], v[96:99], v[212:215], v[32:47]
  s_add_u32 s3, s68, 0
  s_and_b32 s3, s3, 15
  s_lshl_b32 s67, s52, 4
  s_add_u32 s3, s3, s67
  s_lshl_b32 s3, s3, 14
  s_add_u32 s67, s3, s25
  s_add_u32 m0, s56, 0
  s_add_u32 s57, s67, 0
  buffer_load_dwordx4 v2, s[40:43], s57 offen offset:0 lds
  s_setprio 2
  s_waitcnt vmcnt(1)
  v_cmp_eq_u64 vcc, v[86:87], v[14:15]
  s_nop 0
  s_cmp_eq_u64 vcc, -1
  s_cbranch_scc0 fl26_slow
fl26_ok:
  s_setprio 0
  s_add_u32 s58, s58, 131072
  ds_read_b64_tr_b16 v[96:97], v12 offset:3136
  ds_read_b64_tr_b16 v[98:99], v12 offset:3520
  s_waitcnt lgkmcnt(7)
  v_mfma_f32_32x32x16_bf16 v[48:63], v[100:103], v[212:215], v[48:63]
  buffer_load_dwordx4 v3, s[40:43], s57 offen offset:1024 lds
  ds_read_b32 v7, v5
  ds_read_b64_tr_b16 v[100:101], v12 offset:4608
  ds_read_b64_tr_b16 v[102:103], v12 offset:4992
  s_waitcnt lgkmcnt(7)
  v_mfma_f32_32x32x16_bf16 v[16:31], v[104:107], v[216:219], v[16:31]
  s_add_u32 m0, s56, 2048
  s_add_u32 s57, s67, 16384
  buffer_load_dwordx4 v2, s[40:43], s57 offen offset:0 lds
  ds_read_b64_tr_b16 v[104:105], v12 offset:4640
  ds_read_b64_tr_b16 v[106:107], v12 offset:5024
  s_waitcnt lgkmcnt(7)
  v_mfma_f32_32x32x16_bf16 v[32:47], v[108:111], v[216:219], v[32:47]
  buffer_load_dwordx4 v3, s[40:43], s57 offen offset:1024 lds
  ds_read_b64_tr_b16 v[108:109], v12 offset:4672
  ds_read_b64_tr_b16 v[110:111], v12 offset:5056
  s_waitcnt lgkmcnt(7)
  v_mfma_f32_32x32x16_bf16 v[48:63], v[96:99], v[216:219], v[48:63]
  s_add_u32 s3, s68, 2
  s_and_b32 s3, s3, 15
  s_lshl_b32 s67, s52, 4
  s_add_u32 s3, s3, s67
  s_lshl_b32 s3, s3, 14
  s_add_u32 s67, s3, s25
  s_add_u32 m0, s56, 4096
  s_add_u32 s57, s67, 0
  buffer_load_dwordx4 v2, s[40:43], s57 offen offset:0 lds
  s_setprio 2
  s_waitcnt lgkmcnt(6)
  v_cmp_le_u32 vcc, 18, v7
  s_nop 0
  s_cmp_eq_u64 vcc, -1
  s_cbranch_scc0 sig27_slow
sig27_ok:
  s_setprio 0
  ds_read_b64_tr_b16 v[96:97], v12 offset:12416
  ds_read_b64_tr_b16 v[98:99], v12 offset:12800
  s_waitcnt lgkmcnt(6)
  v_mfma_f32_32x32x16_bf16 v[16:31], v[100:103], v[220:223], v[16:31]
  buffer_load_dwordx4 v3, s[40:43], s57 offen offset:1024 lds
  ds_read_b64_tr_b16 v[100:101], v12 offset:12448
  ds_read_b64_tr_b16 v[102:103], v12 offset:12832
  s_waitcnt lgkmcnt(6)
  v_mfma_f32_32x32x16_bf16 v[32:47], v[104:107], v[220:223], v[32:47]
  s_add_u32 m0, s56, 6144
  s_add_u32 s57, s67, 16384
  buffer_load_dwordx4 v2, s[40:43], s57 offen offset:0 lds
  ds_read_b64_tr_b16 v[104:105], v12 offset:12480
  ds_read_b64_tr_b16 v[106:107], v12 offset:12864
  s_waitcnt lgkmcnt(6)
  v_mfma_f32_32x32x16_bf16 v[48:63], v[108:111], v[220:223], v[48:63]
  buffer_load_dwordx4 v3, s[40:43], s57 offen offset:1024 lds
PADa_22:
  s_cbranch_execz PADa_26
  ds_read_b64_tr_b16 v[108:109], v12 offset:13952
  ds_read_b64_tr_b16 v[110:111], v12 offset:14336
  s_waitcnt lgkmcnt(6)
  v_mfma_f32_32x32x16_bf16 v[16:31], v[96:99], v[224:227], v[16:31]
  ds_read_b64_tr_b16 v[96:97], v12 offset:13984
  ds_read_b64_tr_b16 v[98:99], v12 offset:14368
  s_waitcnt lgkmcnt(6)
  v_mfma_f32_32x32x16_bf16 v[32:47], v[100:103], v[224:227], v[32:47]
  ds_read_b64_tr_b16 v[100:101], v12 offset:14016
  ds_read_b64_tr_b16 v[102:103], v12 offset:14400
  s_waitcnt lgkmcnt(6)
  v_mfma_f32_32x32x16_bf16 v[48:63], v[104:107], v[224:227], v[48:63]
  s_setprio 2
  v_mov_b32 v6, 19
  ds_write_b32 v4, v6
  s_setprio 0
  ds_read_b64_tr_b16 v[104:105], v12 offset:15488
  ds_read_b64_tr_b16 v[106:107], v12 offset:15872
  s_waitcnt lgkmcnt(7)
  v_mfma_f32_32x32x16_bf16 v[16:31], v[108:111], v[228:231], v[16:31]
  ds_read_b64_tr_b16 v[108:109], v12 offset:15520
  ds_read_b64_tr_b16 v[110:111], v12 offset:15904
  s_waitcnt lgkmcnt(7)
  v_mfma_f32_32x32x16_bf16 v[32:47], v[96:99], v[228:231], v[32:47]
  ds_read_b64_tr_b16 v[96:97], v12 offset:15552
  ds_read_b64_tr_b16 v[98:99], v12 offset:15936
  s_waitcnt lgkmcnt(7)
  v_mfma_f32_32x32x16_bf16 v[48:63], v[100:103], v[228:231], v[48:63]
  ds_read_b32 v7, v5
  ds_read_b64_tr_b16 v[100:101], v12 offset:17024
  ds_read_b64_tr_b16 v[102:103], v12 offset:17408
  s_waitcnt lgkmcnt(7)
  v_mfma_f32_32x32x16_bf16 v[16:31], v[104:107], v[232:235], v[16:31]
  s_add_u32 s3, s68, 0
  s_and_b32 s3, s3, 15
  s_lshl_b32 s26, s52, 4
  s_add_u32 s3, s3, s26
  s_lshl_b32 s3, s3, 10
  s_add_u32 s26, s3, s59
  buffer_load_dwordx4 v[128:131], v80, s[36:39], s26 offen offset:0 sc1
  ds_read_b64_tr_b16 v[104:105], v12 offset:17056
  ds_read_b64_tr_b16 v[106:107], v12 offset:17440
  s_waitcnt lgkmcnt(7)
  v_mfma_f32_32x32x16_bf16 v[32:47], v[108:111], v[232:235], v[32:47]
  buffer_load_dwordx4 v[132:135], v81, s[36:39], s26 offen offset:0 sc1
  ds_read_b64_tr_b16 v[108:109], v12 offset:17088
  ds_read_b64_tr_b16 v[110:111], v12 offset:17472
  s_waitcnt lgkmcnt(7)
  v_mfma_f32_32x32x16_bf16 v[48:63], v[96:99], v[232:235], v[48:63]
  buffer_load_dwordx4 v[136:139], v80, s[36:39], s26 offen offset:1024 sc1
  s_setprio 2
  s_waitcnt lgkmcnt(6)
  v_cmp_le_u32 vcc, 19, v7
  s_nop 0
  s_cmp_eq_u64 vcc, -1
  s_cbranch_scc0 sig28_slow
sig28_ok:
  s_setprio 0
  ds_read_b64_tr_b16 v[96:97], v12 offset:24832
  ds_read_b64_tr_b16 v[98:99], v12 offset:25216
  s_waitcnt lgkmcnt(6)
  v_mfma_f32_32x32x16_bf16 v[16:31], v[100:103], v[236:239], v[16:31]
  buffer_load_dwordx4 v[140:143], v81, s[36:39], s26 offen offset:1024 sc1
  ds_read_b64_tr_b16 v[100:101], v12 offset:24864
  ds_read_b64_tr_b16 v[102:103], v12 offset:25248
  s_waitcnt lgkmcnt(6)
  v_mfma_f32_32x32x16_bf16 v[32:47], v[104:107], v[236:239], v[32:47]
  s_add_u32 s3, s68, 2
  s_and_b32 s3, s3, 15
  s_lshl_b32 s26, s52, 4
  s_add_u32 s3, s3, s26
  s_lshl_b32 s3, s3, 10
  s_add_u32 s26, s3, s59
PADa_23:
  s_cbranch_execz PADa_27
  buffer_load_dwordx4 v[144:147], v80, s[36:39], s26 offen offset:0 sc1
  ds_read_b64_tr_b16 v[104:105], v12 offset:24896
  ds_read_b64_tr_b16 v[106:107], v12 offset:25280
  s_waitcnt lgkmcnt(6)
  v_mfma_f32_32x32x16_bf16 v[48:63], v[108:111], v[236:239], v[48:63]
  buffer_load_dwordx4 v[148:151], v81, s[36:39], s26 offen offset:0 sc1
  ds_read_b64_tr_b16 v[108:109], v12 offset:26368
  ds_read_b64_tr_b16 v[110:111], v12 offset:26752
  s_waitcnt lgkmcnt(6)
  v_mfma_f32_32x32x16_bf16 v[16:31], v[96:99], v[240:243], v[16:31]
  buffer_load_dwordx4 v[152:155], v80, s[36:39], s26 offen offset:1024 sc1
  ds_read_b64_tr_b16 v[96:97], v12 offset:26400
  ds_read_b64_tr_b16 v[98:99], v12 offset:26784
  s_waitcnt lgkmcnt(6)
  v_mfma_f32_32x32x16_bf16 v[32:47], v[100:103], v[240:243], v[32:47]
  buffer_load_dwordx4 v[156:159], v81, s[36:39], s26 offen offset:1024 sc1
  ds_read_b64_tr_b16 v[100:101], v12 offset:26432
  ds_read_b64_tr_b16 v[102:103], v12 offset:26816
  s_waitcnt lgkmcnt(6)
  v_mfma_f32_32x32x16_bf16 v[48:63], v[104:107], v[240:243], v[48:63]
  ds_read_b64_tr_b16 v[104:105], v12 offset:27904
  ds_read_b64_tr_b16 v[106:107], v12 offset:28288
  s_waitcnt lgkmcnt(6)
  v_mfma_f32_32x32x16_bf16 v[16:31], v[108:111], v[244:247], v[16:31]
  ds_read_b64_tr_b16 v[108:109], v12 offset:27936
  ds_read_b64_tr_b16 v[110:111], v12 offset:28320
  s_waitcnt lgkmcnt(6)
  v_mfma_f32_32x32x16_bf16 v[32:47], v[96:99], v[244:247], v[32:47]
  ds_read_b64_tr_b16 v[96:97], v12 offset:27968
  ds_read_b64_tr_b16 v[98:99], v12 offset:28352
  s_waitcnt lgkmcnt(6)
  v_mfma_f32_32x32x16_bf16 v[48:63], v[100:103], v[244:247], v[48:63]
  ds_read_b64_tr_b16 v[100:101], v12 offset:29440
  ds_read_b64_tr_b16 v[102:103], v12 offset:29824
  s_waitcnt lgkmcnt(6)
  v_mfma_f32_32x32x16_bf16 v[16:31], v[104:107], v[248:251], v[16:31]
  ds_read_b64_tr_b16 v[104:105], v12 offset:29472
  ds_read_b64_tr_b16 v[106:107], v12 offset:29856
  s_waitcnt lgkmcnt(6)
  v_mfma_f32_32x32x16_bf16 v[32:47], v[108:111], v[248:251], v[32:47]
  ds_read_b64_tr_b16 v[108:109], v12 offset:29504
  ds_read_b64_tr_b16 v[110:111], v12 offset:29888
  s_waitcnt lgkmcnt(6)
  v_mfma_f32_32x32x16_bf16 v[48:63], v[96:99], v[248:251], v[48:63]
  s_waitcnt lgkmcnt(4)
  v_mfma_f32_32x32x16_bf16 v[16:31], v[100:103], v[252:255], v[16:31]
  s_waitcnt lgkmcnt(2)
  v_mfma_f32_32x32x16_bf16 v[32:47], v[104:107], v[252:255], v[32:47]
  s_waitcnt lgkmcnt(0)
  v_mfma_f32_32x32x16_bf16 v[48:63], v[108:111], v[252:255], v[48:63]
  s_setprio 2
  v_mov_b32 v6, 20
  ds_write_b32 v4, v6
PADa_24:
  s_cbranch_execz PADa_28
  s_setprio 2
  s_mul_i32 s3, s54, 3072
  s_add_u32 s3, s3, 65536
  s_add_u32 s57, s3, s65
  s_nop 4
  v_max_f32 v16, 0, v16
  v_max_f32 v17, 0, v17
  v_max_f32 v18, 0, v18
  v_max_f32 v19, 0, v19
  v_max_f32 v20, 0, v20
  v_max_f32 v21, 0, v21
  v_max_f32 v22, 0, v22
  v_max_f32 v23, 0, v23
  v_mul_f32 v16, v16, v24
  v_mul_f32 v17, v17, v25
  v_mul_f32 v18, v18, v26
  v_mul_f32 v19, v19, v27
  v_mul_f32 v20, v20, v28
  v_mul_f32 v21, v21, v29
  v_mul_f32 v22, v22, v30
  v_mul_f32 v23, v23, v31
  v_mul_f32 v16, v16, v95
  v_mul_f32 v17, v17, v95
  v_mul_f32 v18, v18, v95
  v_mul_f32 v19, v19, v95
  v_mul_f32 v20, v20, v95
  v_mul_f32 v21, v21, v95
  v_mul_f32 v22, v22, v95
  v_mul_f32 v23, v23, v95
  v_cvt_pk_bf16_f32 v112, v16, v17
  v_cvt_pk_bf16_f32 v113, v18, v19
  v_cvt_pk_bf16_f32 v114, v20, v21
  v_cvt_pk_bf16_f32 v115, v22, v23
  buffer_store_dwordx4 v[112:115], v1, s[36:39], s57 offen offset:0 sc1
  v_max_f32 v32, 0, v32
  v_max_f32 v33, 0, v33
  v_max_f32 v34, 0, v34
  v_max_f32 v35, 0, v35
  v_max_f32 v36, 0, v36
  v_max_f32 v37, 0, v37
  v_max_f32 v38, 0, v38
  v_max_f32 v39, 0, v39
  v_mul_f32 v32, v32, v40
  v_mul_f32 v33, v33, v41
  v_mul_f32 v34, v34, v42
  v_mul_f32 v35, v35, v43
  v_mul_f32 v36, v36, v44
  v_mul_f32 v37, v37, v45
  v_mul_f32 v38, v38, v46
  v_mul_f32 v39, v39, v47
  v_mul_f32 v32, v32, v95
  v_mul_f32 v33, v33, v95
  v_mul_f32 v34, v34, v95
  v_mul_f32 v35, v35, v95
  v_mul_f32 v36, v36, v95
  v_mul_f32 v37, v37, v95
  v_mul_f32 v38, v38, v95
  v_mul_f32 v39, v39, v95
  v_cvt_pk_bf16_f32 v116, v32, v33
  v_cvt_pk_bf16_f32 v117, v34, v35
  v_cvt_pk_bf16_f32 v118, v36, v37
  v_cvt_pk_bf16_f32 v119, v38, v39
  buffer_store_dwordx4 v[116:119], v1, s[36:39], s57 offen offset:1024 sc1
  v_max_f32 v48, 0, v48
  v_max_f32 v49, 0, v49
  v_max_f32 v50, 0, v50
  v_max_f32 v51, 0, v51
  v_max_f32 v52, 0, v52
  v_max_f32 v53, 0, v53
  v_max_f32 v54, 0, v54
  v_max_f32 v55, 0, v55
  v_mul_f32 v48, v48, v56
  v_mul_f32 v49, v49, v57
  v_mul_f32 v50, v50, v58
  v_mul_f32 v51, v51, v59
  v_mul_f32 v52, v52, v60
  v_mul_f32 v53, v53, v61
  v_mul_f32 v54, v54, v62
  v_mul_f32 v55, v55, v63
  v_mul_f32 v48, v48, v95
  v_mul_f32 v49, v49, v95
  v_mul_f32 v50, v50, v95
  v_mul_f32 v51, v51, v95
  v_mul_f32 v52, v52, v95
  v_mul_f32 v53, v53, v95
  v_mul_f32 v54, v54, v95
  v_mul_f32 v55, v55, v95
  v_cvt_pk_bf16_f32 v120, v48, v49
  v_cvt_pk_bf16_f32 v121, v50, v51
  v_cvt_pk_bf16_f32 v122, v52, v53
  v_cvt_pk_bf16_f32 v123, v54, v55
  buffer_store_dwordx4 v[120:123], v1, s[36:39], s57 offen offset:2048 sc1
  s_setprio 0
  s_setprio 2
PADa_25:
  s_cbranch_execz PADa_29
  v_lshlrev_b32 v16, 16, v64
  v_and_b32 v17, 0xffff0000, v64
  v_lshlrev_b32 v18, 16, v65
  v_and_b32 v19, 0xffff0000, v65
  v_lshlrev_b32 v20, 16, v66
  v_and_b32 v21, 0xffff0000, v66
  v_lshlrev_b32 v22, 16, v67
  v_and_b32 v23, 0xffff0000, v67
  v_lshlrev_b32 v24, 16, v68
  v_and_b32 v25, 0xffff0000, v68
  v_lshlrev_b32 v26, 16, v69
  v_and_b32 v27, 0xffff0000, v69
  v_lshlrev_b32 v28, 16, v70
  v_and_b32 v29, 0xffff0000, v70
  v_lshlrev_b32 v30, 16, v71
  v_and_b32 v31, 0xffff0000, v71
  v_mov_b32 v85, 0
  s_add_u32 s66, s66, 131072
  s_setprio 0
  s_waitcnt vmcnt(17)
  ds_read_b64_tr_b16 v[192:193], v82 offset:0
  ds_read_b64_tr_b16 v[194:195], v82 offset:1024
  ds_read_b64_tr_b16 v[196:197], v83 offset:0
  ds_read_b64_tr_b16 v[198:199], v83 offset:1024
  s_waitcnt vmcnt(15)
  ds_read_b64_tr_b16 v[200:201], v82 offset:2048
  ds_read_b64_tr_b16 v[202:203], v82 offset:3072
  ds_read_b64_tr_b16 v[204:205], v83 offset:2048
  ds_read_b64_tr_b16 v[206:207], v83 offset:3072
  s_waitcnt lgkmcnt(4)
  s_waitcnt vmcnt(9)
  v_mfma_f32_32x32x16_bf16 v[16:31], v[192:195], v[128:131], v[16:31]
  ds_read_b64_tr_b16 v[208:209], v82 offset:4096
  s_add_u32 s3, s68, 4
  s_and_b32 s3, s3, 15
  s_lshl_b32 s26, s52, 4
  s_add_u32 s3, s3, s26
  s_lshl_b32 s3, s3, 10
  s_add_u32 s26, s3, s59
  buffer_load_dwordx4 v[160:163], v80, s[36:39], s26 offen offset:0 sc1
  v_mfma_f32_32x32x16_bf16 v[32:47], v[192:195], v[132:135], 0
  ds_read_b64_tr_b16 v[210:211], v82 offset:5120
  buffer_load_dwordx4 v[164:167], v81, s[36:39], s26 offen offset:0 sc1
  v_mfma_f32_32x32x16_bf16 v[48:63], v[196:199], v[128:131], 0
  ds_read_b64_tr_b16 v[212:213], v83 offset:4096
  s_add_u32 s3, s68, 4
  s_and_b32 s3, s3, 15
  s_lshl_b32 s67, s52, 4
  s_add_u32 s3, s3, s67
  s_lshl_b32 s3, s3, 14
  s_add_u32 s67, s3, s25
  s_add_u32 m0, s56, 8192
  s_add_u32 s57, s67, 0
  buffer_load_dwordx4 v2, s[40:43], s57 offen offset:0 lds
  v_mfma_f32_32x32x16_bf16 v[64:79], v[196:199], v[132:135], 0
  ds_read_b64_tr_b16 v[214:215], v83 offset:5120
  buffer_load_dwordx4 v3, s[40:43], s57 offen offset:1024 lds
  s_waitcnt vmcnt(4)
  s_mov_b64 exec, 1
  buffer_store_dwordx2 v[14:15], v85, s[36:39], s66 offen sc1
  s_mov_b64 exec, -1
  s_waitcnt lgkmcnt(4)
  v_mfma_f32_32x32x16_bf16 v[16:31], v[200:203], v[136:139], v[16:31]
  ds_read_b64_tr_b16 v[216:217], v82 offset:6144
  buffer_load_dwordx4 v[168:171], v80, s[36:39], s26 offen offset:1024 sc1
  v_mfma_f32_32x32x16_bf16 v[32:47], v[200:203], v[140:143], v[32:47]
  ds_read_b64_tr_b16 v[218:219], v82 offset:7168
  buffer_load_dwordx4 v[172:175], v81, s[36:39], s26 offen offset:1024 sc1
  v_mfma_f32_32x32x16_bf16 v[48:63], v[204:207], v[136:139], v[48:63]
  ds_read_b64_tr_b16 v[220:221], v83 offset:6144
  s_add_u32 m0, s56, 10240
PADa_26:
  s_cbranch_execz PADa_30
  s_add_u32 s57, s67, 16384
  buffer_load_dwordx4 v2, s[40:43], s57 offen offset:0 lds
  v_mfma_f32_32x32x16_bf16 v[64:79], v[204:207], v[140:143], v[64:79]
  ds_read_b64_tr_b16 v[222:223], v83 offset:7168
  buffer_load_dwordx4 v3, s[40:43], s57 offen offset:1024 lds
  ds_read_b32 v7, v5
  s_waitcnt lgkmcnt(5)
  v_mfma_f32_32x32x16_bf16 v[16:31], v[208:211], v[144:147], v[16:31]
  s_waitcnt vmcnt(5)
  ds_read_b64_tr_b16 v[224:225], v82 offset:8192
  s_add_u32 s3, s68, 6
  s_and_b32 s3, s3, 15
  s_lshl_b32 s26, s52, 4
  s_add_u32 s3, s3, s26
  s_lshl_b32 s3, s3, 10
  s_add_u32 s26, s3, s59
  buffer_load_dwordx4 v[176:179], v80, s[36:39], s26 offen offset:0 sc1
  v_mfma_f32_32x32x16_bf16 v[32:47], v[208:211], v[148:151], v[32:47]
  ds_read_b64_tr_b16 v[226:227], v82 offset:9216
  buffer_load_dwordx4 v[180:183], v81, s[36:39], s26 offen offset:0 sc1
  v_mfma_f32_32x32x16_bf16 v[48:63], v[212:215], v[144:147], v[48:63]
  ds_read_b64_tr_b16 v[228:229], v83 offset:8192
  s_add_u32 s3, s68, 6
  s_and_b32 s3, s3, 15
  s_lshl_b32 s67, s52, 4
  s_add_u32 s3, s3, s67
  s_lshl_b32 s3, s3, 14
  s_add_u32 s67, s3, s25
  s_add_u32 m0, s56, 12288
  s_add_u32 s57, s67, 0
  buffer_load_dwordx4 v2, s[40:43], s57 offen offset:0 lds
  v_mfma_f32_32x32x16_bf16 v[64:79], v[212:215], v[148:151], v[64:79]
  ds_read_b64_tr_b16 v[230:231], v83 offset:9216
  buffer_load_dwordx4 v3, s[40:43], s57 offen offset:1024 lds
  s_setprio 2
  s_waitcnt lgkmcnt(4)
  v_cmp_le_u32 vcc, 20, v7
  s_nop 0
  s_cmp_eq_u64 vcc, -1
  s_cbranch_scc0 sig29_slow
sig29_ok:
  s_and_b32 s72, s52, 1
  s_lshr_b32 s73, s52, 1
  s_add_u32 s62, s62, s72
  s_lshl_b32 s3, s62, 1
  s_add_u32 s3, s3, s73
  s_lshl_b32 s74, s3, 14
  s_add_u32 s74, s74, 8388608
  s_lshl_b32 s3, s3, 11
  s_add_u32 s75, s3, 6684672
  v_and_b32 v8, 15, v0
  v_lshlrev_b32 v10, 7, v8
  v_add_u32 v9, 1024, v5
  s_xor_b32 s72, s52, 2
  s_lshl_b32 s3, s72, 12
  s_add_u32 s3, s3, 49152
  v_add_u32 v93, s3, v1
  s_lshl_b32 s3, s72, 8
  s_add_u32 s3, s3, 160256
  v_lshl_add_u32 v94, v0, 2, s3
  s_xor_b32 s3, s52, 1
  s_mul_i32 s3, s3, 12288
  s_add_u32 s3, s3, 0
  v_add_u32 v89, s3, v1
  s_xor_b32 s3, s52, 2
  s_mul_i32 s3, s3, 12288
  s_add_u32 s3, s3, 4096
  v_add_u32 v90, s3, v1
  s_xor_b32 s3, s52, 3
  s_mul_i32 s3, s3, 12288
  s_add_u32 s3, s3, 8192
  v_add_u32 v91, s3, v1
  s_mul_i32 s3, s52, 12288
  s_add_u32 s3, s3, 0
  v_add_u32 v92, s3, v1
  s_setprio 0
  v_mfma_f32_32x32x16_bf16 v[16:31], v[216:219], v[152:155], v[16:31]
  s_waitcnt vmcnt(4)
  ds_read_b64_tr_b16 v[232:233], v82 offset:10240
PADa_27:
  s_cbranch_execz PADa_31
  buffer_load_dwordx4 v[184:187], v80, s[36:39], s26 offen offset:1024 sc1
  v_mfma_f32_32x32x16_bf16 v[32:47], v[216:219], v[156:159], v[32:47]
  ds_read_b64_tr_b16 v[234:235], v82 offset:11264
  buffer_load_dwordx4 v[188:191], v81, s[36:39], s26 offen offset:1024 sc1
  v_mfma_f32_32x32x16_bf16 v[48:63], v[220:223], v[152:155], v[48:63]
  ds_read_b64_tr_b16 v[236:237], v83 offset:10240
  s_add_u32 m0, s56, 14336
  s_add_u32 s57, s67, 16384
  buffer_load_dwordx4 v2, s[40:43], s57 offen offset:0 lds
  v_mfma_f32_32x32x16_bf16 v[64:79], v[220:223], v[156:159], v[64:79]
  ds_read_b64_tr_b16 v[238:239], v83 offset:11264
  buffer_load_dwordx4 v3, s[40:43], s57 offen offset:1024 lds
  s_waitcnt lgkmcnt(4)
  v_mfma_f32_32x32x16_bf16 v[16:31], v[224:227], v[160:163], v[16:31]
  s_waitcnt vmcnt(4)
  ds_read_b64_tr_b16 v[240:241], v82 offset:12288
  s_add_u32 s3, s68, 8
  s_and_b32 s3, s3, 15
  s_lshl_b32 s26, s52, 4
  s_add_u32 s3, s3, s26
  s_lshl_b32 s3, s3, 10
  s_add_u32 s26, s3, s59
  buffer_load_dwordx4 v[128:131], v80, s[36:39], s26 offen offset:0 sc1
  v_mfma_f32_32x32x16_bf16 v[32:47], v[224:227], v[164:167], v[32:47]
  ds_read_b64_tr_b16 v[242:243], v82 offset:13312
  buffer_load_dwordx4 v[132:135], v81, s[36:39], s26 offen offset:0 sc1
  v_mfma_f32_32x32x16_bf16 v[48:63], v[228:231], v[160:163], v[48:63]
  ds_read_b64_tr_b16 v[244:245], v83 offset:12288
  s_add_u32 s3, s68, 8
  s_and_b32 s3, s3, 15
  s_lshl_b32 s67, s52, 4
  s_add_u32 s3, s3, s67
  s_lshl_b32 s3, s3, 14
  s_add_u32 s67, s3, s25
  s_add_u32 m0, s56, 0
  s_add_u32 s57, s67, 0
  buffer_load_dwordx4 v2, s[40:43], s57 offen offset:0 lds
  v_mfma_f32_32x32x16_bf16 v[64:79], v[228:231], v[164:167], v[64:79]
  ds_read_b64_tr_b16 v[246:247], v83 offset:13312
  buffer_load_dwordx4 v3, s[40:43], s57 offen offset:1024 lds
  s_waitcnt lgkmcnt(4)
  v_mfma_f32_32x32x16_bf16 v[16:31], v[232:235], v[168:171], v[16:31]
  s_waitcnt vmcnt(4)
  ds_read_b64_tr_b16 v[248:249], v82 offset:14336
  buffer_load_dwordx4 v[136:139], v80, s[36:39], s26 offen offset:1024 sc1
  v_mfma_f32_32x32x16_bf16 v[32:47], v[232:235], v[172:175], v[32:47]
  ds_read_b64_tr_b16 v[250:251], v82 offset:15360
  buffer_load_dwordx4 v[140:143], v81, s[36:39], s26 offen offset:1024 sc1
  v_mfma_f32_32x32x16_bf16 v[48:63], v[236:239], v[168:171], v[48:63]
  ds_read_b64_tr_b16 v[252:253], v83 offset:14336
  s_add_u32 m0, s56, 2048
  s_add_u32 s57, s67, 16384
  buffer_load_dwordx4 v2, s[40:43], s57 offen offset:0 lds
  v_mfma_f32_32x32x16_bf16 v[64:79], v[236:239], v[172:175], v[64:79]
  ds_read_b64_tr_b16 v[254:255], v83 offset:15360
  buffer_load_dwordx4 v3, s[40:43], s57 offen offset:1024 lds
  s_waitcnt lgkmcnt(4)
  v_mfma_f32_32x32x16_bf16 v[16:31], v[240:243], v[176:179], v[16:31]
  s_waitcnt vmcnt(4)
  ds_read_b64_tr_b16 v[192:193], v82 offset:0
  s_add_u32 s3, s68, 10
  s_and_b32 s3, s3, 15
  s_lshl_b32 s26, s52, 4
  s_add_u32 s3, s3, s26
  s_lshl_b32 s3, s3, 10
  s_add_u32 s26, s3, s59
  buffer_load_dwordx4 v[144:147], v80, s[36:39], s26 offen offset:0 sc1
  v_mfma_f32_32x32x16_bf16 v[32:47], v[240:243], v[180:183], v[32:47]
PADa_28:
  s_cbranch_execz PADa_32
  ds_read_b64_tr_b16 v[194:195], v82 offset:1024
  buffer_load_dwordx4 v[148:151], v81, s[36:39], s26 offen offset:0 sc1
  v_mfma_f32_32x32x16_bf16 v[48:63], v[244:247], v[176:179], v[48:63]
  ds_read_b64_tr_b16 v[196:197], v83 offset:0
  s_add_u32 s3, s68, 10
  s_and_b32 s3, s3, 15
  s_lshl_b32 s67, s52, 4
  s_add_u32 s3, s3, s67
  s_lshl_b32 s3, s3, 14
  s_add_u32 s67, s3, s25
  s_add_u32 m0, s56, 4096
  s_add_u32 s57, s67, 0
  buffer_load_dwordx4 v2, s[40:43], s57 offen offset:0 lds
  v_mfma_f32_32x32x16_bf16 v[64:79], v[244:247], v[180:183], v[64:79]
  ds_read_b64_tr_b16 v[198:199], v83 offset:1024
  buffer_load_dwordx4 v3, s[40:43], s57 offen offset:1024 lds
  s_waitcnt lgkmcnt(4)
  v_mfma_f32_32x32x16_bf16 v[16:31], v[248:251], v[184:187], v[16:31]
  s_waitcnt vmcnt(4)
  ds_read_b64_tr_b16 v[200:201], v82 offset:2048
  buffer_load_dwordx4 v[152:155], v80, s[36:39], s26 offen offset:1024 sc1
  v_mfma_f32_32x32x16_bf16 v[32:47], v[248:251], v[188:191], v[32:47]
  ds_read_b64_tr_b16 v[202:203], v82 offset:3072
  buffer_load_dwordx4 v[156:159], v81, s[36:39], s26 offen offset:1024 sc1
  v_mfma_f32_32x32x16_bf16 v[48:63], v[252:255], v[184:187], v[48:63]
  ds_read_b64_tr_b16 v[204:205], v83 offset:2048
  s_add_u32 m0, s56, 6144
  s_add_u32 s57, s67, 16384
  buffer_load_dwordx4 v2, s[40:43], s57 offen offset:0 lds
  v_mfma_f32_32x32x16_bf16 v[64:79], v[252:255], v[188:191], v[64:79]
  ds_read_b64_tr_b16 v[206:207], v83 offset:3072
  buffer_load_dwordx4 v3, s[40:43], s57 offen offset:1024 lds
  buffer_load_dwordx2 v[86:87], v84, s[36:39], s58 offen sc1
  s_waitcnt lgkmcnt(4)
  v_mfma_f32_32x32x16_bf16 v[16:31], v[192:195], v[128:131], v[16:31]
  s_waitcnt vmcnt(5)
  ds_read_b64_tr_b16 v[208:209], v82 offset:4096
  s_add_u32 s3, s68, 12
  s_and_b32 s3, s3, 15
  s_lshl_b32 s26, s52, 4
  s_add_u32 s3, s3, s26
  s_lshl_b32 s3, s3, 10
  s_add_u32 s26, s3, s59
  buffer_load_dwordx4 v[160:163], v80, s[36:39], s26 offen offset:0 sc1
  v_mfma_f32_32x32x16_bf16 v[32:47], v[192:195], v[132:135], v[32:47]
  ds_read_b64_tr_b16 v[210:211], v82 offset:5120
  buffer_load_dwordx4 v[164:167], v81, s[36:39], s26 offen offset:0 sc1
  v_mfma_f32_32x32x16_bf16 v[48:63], v[196:199], v[128:131], v[48:63]
  ds_read_b64_tr_b16 v[212:213], v83 offset:4096
  s_add_u32 s3, s68, 12
  s_and_b32 s3, s3, 15
  s_lshl_b32 s67, s52, 4
  s_add_u32 s3, s3, s67
  s_lshl_b32 s3, s3, 14
  s_add_u32 s67, s3, s25
  s_add_u32 m0, s56, 8192
  s_add_u32 s57, s67, 0
  buffer_load_dwordx4 v2, s[40:43], s57 offen offset:0 lds
  v_mfma_f32_32x32x16_bf16 v[64:79], v[196:199], v[132:135], v[64:79]
  ds_read_b64_tr_b16 v[214:215], v83 offset:5120
  buffer_load_dwordx4 v3, s[40:43], s57 offen offset:1024 lds
  s_waitcnt lgkmcnt(4)
  v_mfma_f32_32x32x16_bf16 v[16:31], v[200:203], v[136:139], v[16:31]
  s_waitcnt vmcnt(5)
  ds_read_b64_tr_b16 v[216:217], v82 offset:6144
  buffer_load_dwordx4 v[168:171], v80, s[36:39], s26 offen offset:1024 sc1
  v_mfma_f32_32x32x16_bf16 v[32:47], v[200:203], v[140:143], v[32:47]
  ds_read_b64_tr_b16 v[218:219], v82 offset:7168
PADa_29:
  s_cbranch_execz PADa_33
  buffer_load_dwordx4 v[172:175], v81, s[36:39], s26 offen offset:1024 sc1
  v_mfma_f32_32x32x16_bf16 v[48:63], v[204:207], v[136:139], v[48:63]
  ds_read_b64_tr_b16 v[220:221], v83 offset:6144
  s_add_u32 m0, s56, 10240
  s_add_u32 s57, s67, 16384
  buffer_load_dwordx4 v2, s[40:43], s57 offen offset:0 lds
  v_mfma_f32_32x32x16_bf16 v[64:79], v[204:207], v[140:143], v[64:79]
  ds_read_b64_tr_b16 v[222:223], v83 offset:7168
  buffer_load_dwordx4 v3, s[40:43], s57 offen offset:1024 lds
  s_waitcnt lgkmcnt(4)
  v_mfma_f32_32x32x16_bf16 v[16:31], v[208:211], v[144:147], v[16:31]
  s_waitcnt vmcnt(4)
  ds_read_b64_tr_b16 v[224:225], v82 offset:8192
  s_add_u32 s3, s68, 14
  s_and_b32 s3, s3, 15
  s_lshl_b32 s26, s52, 4
  s_add_u32 s3, s3, s26
  s_lshl_b32 s3, s3, 10
  s_add_u32 s26, s3, s59
  buffer_load_dwordx4 v[176:179], v80, s[36:39], s26 offen offset:0 sc1
  v_mfma_f32_32x32x16_bf16 v[32:47], v[208:211], v[148:151], v[32:47]
  ds_read_b64_tr_b16 v[226:227], v82 offset:9216
  buffer_load_dwordx4 v[180:183], v81, s[36:39], s26 offen offset:0 sc1
  v_mfma_f32_32x32x16_bf16 v[48:63], v[212:215], v[144:147], v[48:63]
  ds_read_b64_tr_b16 v[228:229], v83 offset:8192
  s_add_u32 s3, s68, 14
  s_and_b32 s3, s3, 15
  s_lshl_b32 s67, s52, 4
  s_add_u32 s3, s3, s67
  s_lshl_b32 s3, s3, 14
  s_add_u32 s67, s3, s25
  s_add_u32 m0, s56, 12288
  s_add_u32 s57, s67, 0
  buffer_load_dwordx4 v2, s[40:43], s57 offen offset:0 lds
  v_mfma_f32_32x32x16_bf16 v[64:79], v[212:215], v[148:151], v[64:79]
  ds_read_b64_tr_b16 v[230:231], v83 offset:9216
  buffer_load_dwordx4 v3, s[40:43], s57 offen offset:1024 lds
  s_waitcnt lgkmcnt(4)
  v_mfma_f32_32x32x16_bf16 v[16:31], v[216:219], v[152:155], v[16:31]
  s_waitcnt vmcnt(4)
  ds_read_b64_tr_b16 v[232:233], v82 offset:10240
  buffer_load_dwordx4 v[184:187], v80, s[36:39], s26 offen offset:1024 sc1
  v_mfma_f32_32x32x16_bf16 v[32:47], v[216:219], v[156:159], v[32:47]
  ds_read_b64_tr_b16 v[234:235], v82 offset:11264
  buffer_load_dwordx4 v[188:191], v81, s[36:39], s26 offen offset:1024 sc1
  v_mfma_f32_32x32x16_bf16 v[48:63], v[220:223], v[152:155], v[48:63]
  ds_read_b64_tr_b16 v[236:237], v83 offset:10240
  s_add_u32 m0, s56, 14336
  s_add_u32 s57, s67, 16384
  buffer_load_dwordx4 v2, s[40:43], s57 offen offset:0 lds
  v_mfma_f32_32x32x16_bf16 v[64:79], v[220:223], v[156:159], v[64:79]
  ds_read_b64_tr_b16 v[238:239], v83 offset:11264
  buffer_load_dwordx4 v3, s[40:43], s57 offen offset:1024 lds
  s_setprio 2
  v_cmp_eq_u64 vcc, v[86:87], v[14:15]
  s_nop 0
  s_cmp_eq_u64 vcc, -1
  s_cbranch_scc0 fl30_slow
fl30_ok:
  s_setprio 0
  s_waitcnt lgkmcnt(4)
  v_mfma_f32_32x32x16_bf16 v[16:31], v[224:227], v[160:163], v[16:31]
  s_waitcnt vmcnt(4)
  ds_read_b64_tr_b16 v[240:241], v82 offset:12288
  s_add_u32 s3, s27, 0
  s_sub_u32 s26, s3, 12
  s_cselect_b32 s3, s3, s26
  s_add_u32 s3, s3, 64
  s_mul_i32 s26, s52, 12
  s_add_u32 s3, s3, s26
  s_lshl_b32 s3, s3, 10
  s_add_u32 s26, s3, s59
  buffer_load_dwordx4 v[128:131], v80, s[36:39], s26 offen offset:0 sc1
PADa_30:
  s_cbranch_execz PADa_34
  v_mfma_f32_32x32x16_bf16 v[32:47], v[224:227], v[164:167], v[32:47]
  ds_read_b64_tr_b16 v[242:243], v82 offset:13312
  buffer_load_dwordx4 v[132:135], v81, s[36:39], s26 offen offset:0 sc1
  v_mfma_f32_32x32x16_bf16 v[48:63], v[228:231], v[160:163], v[48:63]
  ds_read_b64_tr_b16 v[244:245], v83 offset:12288
  s_add_u32 s3, s27, 0
  s_sub_u32 s67, s3, 12
  s_cselect_b32 s3, s3, s67
  s_add_u32 s3, s3, 64
  s_mul_i32 s67, s52, 12
  s_add_u32 s3, s3, s67
  s_lshl_b32 s3, s3, 14
  s_add_u32 s67, s3, s25
  s_add_u32 m0, s56, 0
  s_add_u32 s57, s67, 0
  buffer_load_dwordx4 v2, s[40:43], s57 offen offset:0 lds
  v_mfma_f32_32x32x16_bf16 v[64:79], v[228:231], v[164:167], v[64:79]
  ds_read_b64_tr_b16 v[246:247], v83 offset:13312
  buffer_load_dwordx4 v3, s[40:43], s57 offen offset:1024 lds
  s_waitcnt lgkmcnt(4)
  v_mfma_f32_32x32x16_bf16 v[16:31], v[232:235], v[168:171], v[16:31]
  s_waitcnt vmcnt(4)
  ds_read_b64_tr_b16 v[248:249], v82 offset:14336
  buffer_load_dwordx4 v[136:139], v80, s[36:39], s26 offen offset:1024 sc1
  v_mfma_f32_32x32x16_bf16 v[32:47], v[232:235], v[172:175], v[32:47]
  ds_read_b64_tr_b16 v[250:251], v82 offset:15360
  buffer_load_dwordx4 v[140:143], v81, s[36:39], s26 offen offset:1024 sc1
  v_mfma_f32_32x32x16_bf16 v[48:63], v[236:239], v[168:171], v[48:63]
  ds_read_b64_tr_b16 v[252:253], v83 offset:14336
  s_add_u32 m0, s56, 2048
  s_add_u32 s57, s67, 16384
  buffer_load_dwordx4 v2, s[40:43], s57 offen offset:0 lds
  v_mfma_f32_32x32x16_bf16 v[64:79], v[236:239], v[172:175], v[64:79]
  ds_read_b64_tr_b16 v[254:255], v83 offset:15360
  buffer_load_dwordx4 v3, s[40:43], s57 offen offset:1024 lds
  s_waitcnt lgkmcnt(4)
  v_mfma_f32_32x32x16_bf16 v[16:31], v[240:243], v[176:179], v[16:31]
  s_waitcnt vmcnt(4)
  ds_read_b64_tr_b16 v[192:193], v82 offset:0
  s_add_u32 s3, s27, 2
  s_sub_u32 s26, s3, 12
  s_cselect_b32 s3, s3, s26
  s_add_u32 s3, s3, 64
  s_mul_i32 s26, s52, 12
  s_add_u32 s3, s3, s26
  s_lshl_b32 s3, s3, 10
  s_add_u32 s26, s3, s59
  buffer_load_dwordx4 v[144:147], v80, s[36:39], s26 offen offset:0 sc1
  v_mfma_f32_32x32x16_bf16 v[32:47], v[240:243], v[180:183], v[32:47]
  ds_read_b64_tr_b16 v[194:195], v82 offset:1024
  buffer_load_dwordx4 v[148:151], v81, s[36:39], s26 offen offset:0 sc1
  v_mfma_f32_32x32x16_bf16 v[48:63], v[244:247], v[176:179], v[48:63]
  ds_read_b64_tr_b16 v[196:197], v83 offset:0
  s_add_u32 s3, s27, 2
  s_sub_u32 s67, s3, 12
  s_cselect_b32 s3, s3, s67
  s_add_u32 s3, s3, 64
  s_mul_i32 s67, s52, 12
  s_add_u32 s3, s3, s67
  s_lshl_b32 s3, s3, 14
  s_add_u32 s67, s3, s25
  s_add_u32 m0, s56, 4096
  s_add_u32 s57, s67, 0
  buffer_load_dwordx4 v2, s[40:43], s57 offen offset:0 lds
  v_mfma_f32_32x32x16_bf16 v[64:79], v[244:247], v[180:183], v[64:79]
  ds_read_b64_tr_b16 v[198:199], v83 offset:1024
  buffer_load_dwordx4 v3, s[40:43], s57 offen offset:1024 lds
  s_waitcnt lgkmcnt(4)
  v_mfma_f32_32x32x16_bf16 v[16:31], v[248:251], v[184:187], v[16:31]
  s_waitcnt vmcnt(4)
  ds_read_b64_tr_b16 v[200:201], v82 offset:2048
  buffer_load_dwordx4 v[152:155], v80, s[36:39], s26 offen offset:1024 sc1
PADa_31:
  s_cbranch_execz PADa_35
  v_mfma_f32_32x32x16_bf16 v[32:47], v[248:251], v[188:191], v[32:47]
  ds_read_b64_tr_b16 v[202:203], v82 offset:3072
  buffer_load_dwordx4 v[156:159], v81, s[36:39], s26 offen offset:1024 sc1
  v_mfma_f32_32x32x16_bf16 v[48:63], v[252:255], v[184:187], v[48:63]
  ds_read_b64_tr_b16 v[204:205], v83 offset:2048
  s_add_u32 m0, s56, 6144
  s_add_u32 s57, s67, 16384
  buffer_load_dwordx4 v2, s[40:43], s57 offen offset:0 lds
  v_mfma_f32_32x32x16_bf16 v[64:79], v[252:255], v[188:191], v[64:79]
  ds_read_b64_tr_b16 v[206:207], v83 offset:3072
  buffer_load_dwordx4 v3, s[40:43], s57 offen offset:1024 lds
  s_waitcnt lgkmcnt(4)
  v_mfma_f32_32x32x16_bf16 v[16:31], v[192:195], v[128:131], v[16:31]
  s_waitcnt vmcnt(4)
  ds_read_b64_tr_b16 v[208:209], v82 offset:4096
  s_add_u32 s3, s27, 4
  s_sub_u32 s26, s3, 12
  s_cselect_b32 s3, s3, s26
  s_add_u32 s3, s3, 64
  s_mul_i32 s26, s52, 12
  s_add_u32 s3, s3, s26
  s_lshl_b32 s3, s3, 10
  s_add_u32 s26, s3, s59
  buffer_load_dwordx4 v[160:163], v80, s[36:39], s26 offen offset:0 sc1
  v_mfma_f32_32x32x16_bf16 v[32:47], v[192:195], v[132:135], v[32:47]
  ds_read_b64_tr_b16 v[210:211], v82 offset:5120
  buffer_load_dwordx4 v[164:167], v81, s[36:39], s26 offen offset:0 sc1
  v_mfma_f32_32x32x16_bf16 v[48:63], v[196:199], v[128:131], v[48:63]
  ds_read_b64_tr_b16 v[212:213], v83 offset:4096
  s_add_u32 s3, s27, 4
  s_sub_u32 s67, s3, 12
  s_cselect_b32 s3, s3, s67
  s_add_u32 s3, s3, 64
  s_mul_i32 s67, s52, 12
  s_add_u32 s3, s3, s67
  s_lshl_b32 s3, s3, 14
  s_add_u32 s67, s3, s25
  s_add_u32 m0, s56, 8192
  s_add_u32 s57, s67, 0
  buffer_load_dwordx4 v2, s[40:43], s57 offen offset:0 lds
  v_mfma_f32_32x32x16_bf16 v[64:79], v[196:199], v[132:135], v[64:79]
  ds_read_b64_tr_b16 v[214:215], v83 offset:5120
  buffer_load_dwordx4 v3, s[40:43], s57 offen offset:1024 lds
  s_waitcnt lgkmcnt(4)
  v_mfma_f32_32x32x16_bf16 v[16:31], v[200:203], v[136:139], v[16:31]
  s_waitcnt vmcnt(4)
  ds_read_b64_tr_b16 v[216:217], v82 offset:6144
  buffer_load_dwordx4 v[168:171], v80, s[36:39], s26 offen offset:1024 sc1
  v_mfma_f32_32x32x16_bf16 v[32:47], v[200:203], v[140:143], v[32:47]
  ds_read_b64_tr_b16 v[218:219], v82 offset:7168
  buffer_load_dwordx4 v[172:175], v81, s[36:39], s26 offen offset:1024 sc1
  v_mfma_f32_32x32x16_bf16 v[48:63], v[204:207], v[136:139], v[48:63]
  ds_read_b64_tr_b16 v[220:221], v83 offset:6144
  s_add_u32 m0, s56, 10240
  s_add_u32 s57, s67, 16384
  buffer_load_dwordx4 v2, s[40:43], s57 offen offset:0 lds
  v_mfma_f32_32x32x16_bf16 v[64:79], v[204:207], v[140:143], v[64:79]
  ds_read_b64_tr_b16 v[222:223], v83 offset:7168
  buffer_load_dwordx4 v3, s[40:43], s57 offen offset:1024 lds
  s_waitcnt lgkmcnt(4)
  v_mfma_f32_32x32x16_bf16 v[16:31], v[208:211], v[144:147], v[16:31]
  s_waitcnt vmcnt(4)
  ds_read_b64_tr_b16 v[224:225], v82 offset:8192
  s_add_u32 s3, s27, 6
  s_sub_u32 s26, s3, 12
  s_cselect_b32 s3, s3, s26
  s_add_u32 s3, s3, 64
  s_mul_i32 s26, s52, 12
  s_add_u32 s3, s3, s26
  s_lshl_b32 s3, s3, 10
  s_add_u32 s26, s3, s59
PADa_32:
  s_cbranch_execz PADa_36
  buffer_load_dwordx4 v[176:179], v80, s[36:39], s26 offen offset:0 sc1
  v_mfma_f32_32x32x16_bf16 v[32:47], v[208:211], v[148:151], v[32:47]
  ds_read_b64_tr_b16 v[226:227], v82 offset:9216
  buffer_load_dwordx4 v[180:183], v81, s[36:39], s26 offen offset:0 sc1
  v_mfma_f32_32x32x16_bf16 v[48:63], v[212:215], v[144:147], v[48:63]
  ds_read_b64_tr_b16 v[228:229], v83 offset:8192
  s_add_u32 s3, s27, 6
  s_sub_u32 s67, s3, 12
  s_cselect_b32 s3, s3, s67
  s_add_u32 s3, s3, 64
  s_mul_i32 s67, s52, 12
  s_add_u32 s3, s3, s67
  s_lshl_b32 s3, s3, 14
  s_add_u32 s67, s3, s25
  s_add_u32 m0, s56, 12288
  s_add_u32 s57, s67, 0
  buffer_load_dwordx4 v2, s[40:43], s57 offen offset:0 lds
  v_mfma_f32_32x32x16_bf16 v[64:79], v[212:215], v[148:151], v[64:79]
  ds_read_b64_tr_b16 v[230:231], v83 offset:9216
  buffer_load_dwordx4 v3, s[40:43], s57 offen offset:1024 lds
  s_waitcnt lgkmcnt(4)
  v_mfma_f32_32x32x16_bf16 v[16:31], v[216:219], v[152:155], v[16:31]
  s_waitcnt vmcnt(4)
  ds_read_b64_tr_b16 v[232:233], v82 offset:10240
  buffer_load_dwordx4 v[184:187], v80, s[36:39], s26 offen offset:1024 sc1
  v_mfma_f32_32x32x16_bf16 v[32:47], v[216:219], v[156:159], v[32:47]
  ds_read_b64_tr_b16 v[234:235], v82 offset:11264
  buffer_load_dwordx4 v[188:191], v81, s[36:39], s26 offen offset:1024 sc1
  v_mfma_f32_32x32x16_bf16 v[48:63], v[220:223], v[152:155], v[48:63]
  ds_read_b64_tr_b16 v[236:237], v83 offset:10240
  s_add_u32 m0, s56, 14336
  s_add_u32 s57, s67, 16384
  buffer_load_dwordx4 v2, s[40:43], s57 offen offset:0 lds
  v_mfma_f32_32x32x16_bf16 v[64:79], v[220:223], v[156:159], v[64:79]
  ds_read_b64_tr_b16 v[238:239], v83 offset:11264
  buffer_load_dwordx4 v3, s[40:43], s57 offen offset:1024 lds
  s_mov_b32 s58, s75
  s_setprio 2
  v_mov_b32 v84, v10
  s_setprio 0
  s_waitcnt lgkmcnt(4)
  v_mfma_f32_32x32x16_bf16 v[16:31], v[224:227], v[160:163], v[16:31]
  s_waitcnt vmcnt(4)
  ds_read_b64_tr_b16 v[240:241], v82 offset:12288
  s_add_u32 s3, s27, 8
  s_sub_u32 s26, s3, 12
  s_cselect_b32 s3, s3, s26
  s_add_u32 s3, s3, 64
  s_mul_i32 s26, s52, 12
  s_add_u32 s3, s3, s26
  s_lshl_b32 s3, s3, 10
  s_add_u32 s26, s3, s59
  buffer_load_dwordx4 v[128:131], v80, s[36:39], s26 offen offset:0 sc1
  v_mfma_f32_32x32x16_bf16 v[32:47], v[224:227], v[164:167], v[32:47]
  ds_read_b64_tr_b16 v[242:243], v82 offset:13312
  buffer_load_dwordx4 v[132:135], v81, s[36:39], s26 offen offset:0 sc1
  v_mfma_f32_32x32x16_bf16 v[48:63], v[228:231], v[160:163], v[48:63]
  ds_read_b64_tr_b16 v[244:245], v83 offset:12288
  s_add_u32 s3, s27, 8
  s_sub_u32 s67, s3, 12
  s_cselect_b32 s3, s3, s67
  s_add_u32 s3, s3, 64
  s_mul_i32 s67, s52, 12
  s_add_u32 s3, s3, s67
  s_lshl_b32 s3, s3, 14
  s_add_u32 s67, s3, s25
  s_add_u32 m0, s56, 0
  s_add_u32 s57, s67, 0
  buffer_load_dwordx4 v2, s[40:43], s57 offen offset:0 lds
  v_mfma_f32_32x32x16_bf16 v[64:79], v[228:231], v[164:167], v[64:79]
  ds_read_b64_tr_b16 v[246:247], v83 offset:13312
  buffer_load_dwordx4 v3, s[40:43], s57 offen offset:1024 lds
  s_waitcnt lgkmcnt(4)
PADa_33:
  s_cbranch_execz PADa_37
  v_mfma_f32_32x32x16_bf16 v[16:31], v[232:235], v[168:171], v[16:31]
  s_waitcnt vmcnt(4)
  ds_read_b64_tr_b16 v[248:249], v82 offset:14336
  buffer_load_dwordx4 v[136:139], v80, s[36:39], s26 offen offset:1024 sc1
  v_mfma_f32_32x32x16_bf16 v[32:47], v[232:235], v[172:175], v[32:47]
  ds_read_b64_tr_b16 v[250:251], v82 offset:15360
  buffer_load_dwordx4 v[140:143], v81, s[36:39], s26 offen offset:1024 sc1
  v_mfma_f32_32x32x16_bf16 v[48:63], v[236:239], v[168:171], v[48:63]
  ds_read_b64_tr_b16 v[252:253], v83 offset:14336
  s_add_u32 m0, s56, 2048
  s_add_u32 s57, s67, 16384
  buffer_load_dwordx4 v2, s[40:43], s57 offen offset:0 lds
  v_mfma_f32_32x32x16_bf16 v[64:79], v[236:239], v[172:175], v[64:79]
  ds_read_b64_tr_b16 v[254:255], v83 offset:15360
  buffer_load_dwordx4 v3, s[40:43], s57 offen offset:1024 lds
  s_waitcnt lgkmcnt(4)
  v_mfma_f32_32x32x16_bf16 v[16:31], v[240:243], v[176:179], v[16:31]
  s_waitcnt vmcnt(4)
  ds_read_b64_tr_b16 v[192:193], v82 offset:0
  s_add_u32 s3, s27, 10
  s_sub_u32 s26, s3, 12
  s_cselect_b32 s3, s3, s26
  s_add_u32 s3, s3, 64
  s_mul_i32 s26, s52, 12
  s_add_u32 s3, s3, s26
  s_lshl_b32 s3, s3, 10
  s_add_u32 s26, s3, s59
  buffer_load_dwordx4 v[144:147], v80, s[36:39], s26 offen offset:0 sc1
  v_mfma_f32_32x32x16_bf16 v[32:47], v[240:243], v[180:183], v[32:47]
  ds_read_b64_tr_b16 v[194:195], v82 offset:1024
  buffer_load_dwordx4 v[148:151], v81, s[36:39], s26 offen offset:0 sc1
  v_mfma_f32_32x32x16_bf16 v[48:63], v[244:247], v[176:179], v[48:63]
  ds_read_b64_tr_b16 v[196:197], v83 offset:0
  s_add_u32 s3, s27, 10
  s_sub_u32 s67, s3, 12
  s_cselect_b32 s3, s3, s67
  s_add_u32 s3, s3, 64
  s_mul_i32 s67, s52, 12
  s_add_u32 s3, s3, s67
  s_lshl_b32 s3, s3, 14
  s_add_u32 s67, s3, s25
  s_add_u32 m0, s56, 4096
  s_add_u32 s57, s67, 0
  buffer_load_dwordx4 v2, s[40:43], s57 offen offset:0 lds
  v_mfma_f32_32x32x16_bf16 v[64:79], v[244:247], v[180:183], v[64:79]
  ds_read_b64_tr_b16 v[198:199], v83 offset:1024
  buffer_load_dwordx4 v3, s[40:43], s57 offen offset:1024 lds
  s_waitcnt lgkmcnt(4)
  v_mfma_f32_32x32x16_bf16 v[16:31], v[248:251], v[184:187], v[16:31]
  s_waitcnt vmcnt(4)
  ds_read_b64_tr_b16 v[200:201], v82 offset:2048
  buffer_load_dwordx4 v[152:155], v80, s[36:39], s26 offen offset:1024 sc1
  v_mfma_f32_32x32x16_bf16 v[32:47], v[248:251], v[188:191], v[32:47]
  ds_read_b64_tr_b16 v[202:203], v82 offset:3072
  buffer_load_dwordx4 v[156:159], v81, s[36:39], s26 offen offset:1024 sc1
  v_mfma_f32_32x32x16_bf16 v[48:63], v[252:255], v[184:187], v[48:63]
  ds_read_b64_tr_b16 v[204:205], v83 offset:2048
  s_add_u32 m0, s56, 6144
  s_add_u32 s57, s67, 16384
  buffer_load_dwordx4 v2, s[40:43], s57 offen offset:0 lds
  v_mfma_f32_32x32x16_bf16 v[64:79], v[252:255], v[188:191], v[64:79]
  ds_read_b64_tr_b16 v[206:207], v83 offset:3072
  buffer_load_dwordx4 v3, s[40:43], s57 offen offset:1024 lds
  s_waitcnt lgkmcnt(4)
  v_mfma_f32_32x32x16_bf16 v[16:31], v[192:195], v[128:131], v[16:31]
  s_waitcnt vmcnt(4)
  ds_read_b64_tr_b16 v[208:209], v82 offset:4096
  s_mov_b32 s67, s24
PADa_34:
  s_cbranch_execz PADa_38
  s_add_u32 m0, s56, 8192
  s_add_u32 s57, s67, 0
  buffer_load_dwordx4 v2, s[44:47], s57 offen offset:0 lds
  v_mfma_f32_32x32x16_bf16 v[32:47], v[192:195], v[132:135], v[32:47]
  ds_read_b64_tr_b16 v[210:211], v82 offset:5120
  buffer_load_dwordx4 v3, s[44:47], s57 offen offset:1024 lds
  v_mfma_f32_32x32x16_bf16 v[48:63], v[196:199], v[128:131], v[48:63]
  ds_read_b64_tr_b16 v[212:213], v83 offset:4096
  s_add_u32 m0, s56, 10240
  s_add_u32 s57, s67, 16384
  buffer_load_dwordx4 v2, s[44:47], s57 offen offset:0 lds
  v_mfma_f32_32x32x16_bf16 v[64:79], v[196:199], v[132:135], v[64:79]
  ds_read_b64_tr_b16 v[214:215], v83 offset:5120
  buffer_load_dwordx4 v3, s[44:47], s57 offen offset:1024 lds
  s_waitcnt lgkmcnt(4)
  v_mfma_f32_32x32x16_bf16 v[16:31], v[200:203], v[136:139], v[16:31]
  s_waitcnt vmcnt(4)
  ds_read_b64_tr_b16 v[216:217], v82 offset:6144
  s_add_u32 m0, s56, 12288
  s_add_u32 s57, s67, 32768
  buffer_load_dwordx4 v2, s[44:47], s57 offen offset:0 lds
  v_mfma_f32_32x32x16_bf16 v[32:47], v[200:203], v[140:143], v[32:47]
  ds_read_b64_tr_b16 v[218:219], v82 offset:7168
  buffer_load_dwordx4 v3, s[44:47], s57 offen offset:1024 lds
  v_mfma_f32_32x32x16_bf16 v[48:63], v[204:207], v[136:139], v[48:63]
  ds_read_b64_tr_b16 v[220:221], v83 offset:6144
  s_add_u32 m0, s56, 14336
  s_add_u32 s57, s67, 49152
  buffer_load_dwordx4 v2, s[44:47], s57 offen offset:0 lds
  v_mfma_f32_32x32x16_bf16 v[64:79], v[204:207], v[140:143], v[64:79]
  ds_read_b64_tr_b16 v[222:223], v83 offset:7168
  buffer_load_dwordx4 v3, s[44:47], s57 offen offset:1024 lds
  s_waitcnt lgkmcnt(4)
  v_mfma_f32_32x32x16_bf16 v[16:31], v[208:211], v[144:147], v[16:31]
  s_add_u32 m0, s56, 0
  s_add_u32 s57, s67, 65536
  buffer_load_dwordx4 v2, s[44:47], s57 offen offset:0 lds
  v_mfma_f32_32x32x16_bf16 v[32:47], v[208:211], v[148:151], v[32:47]
  buffer_load_dwordx4 v3, s[44:47], s57 offen offset:1024 lds
  v_mfma_f32_32x32x16_bf16 v[48:63], v[212:215], v[144:147], v[48:63]
  s_add_u32 m0, s56, 2048
  s_add_u32 s57, s67, 81920
  buffer_load_dwordx4 v2, s[44:47], s57 offen offset:0 lds
  v_mfma_f32_32x32x16_bf16 v[64:79], v[212:215], v[148:151], v[64:79]
  buffer_load_dwordx4 v3, s[44:47], s57 offen offset:1024 lds
  s_waitcnt lgkmcnt(0)
  v_mfma_f32_32x32x16_bf16 v[16:31], v[216:219], v[152:155], v[16:31]
  s_add_u32 m0, s56, 4096
  s_add_u32 s57, s67, 98304
  buffer_load_dwordx4 v2, s[44:47], s57 offen offset:0 lds
  v_mfma_f32_32x32x16_bf16 v[32:47], v[216:219], v[156:159], v[32:47]
  buffer_load_dwordx4 v3, s[44:47], s57 offen offset:1024 lds
  v_mfma_f32_32x32x16_bf16 v[48:63], v[220:223], v[152:155], v[48:63]
  s_add_u32 m0, s56, 6144
  s_add_u32 s57, s67, 114688
  buffer_load_dwordx4 v2, s[44:47], s57 offen offset:0 lds
  v_mfma_f32_32x32x16_bf16 v[64:79], v[220:223], v[156:159], v[64:79]
  buffer_load_dwordx4 v3, s[44:47], s57 offen offset:1024 lds
PADa_35:
  s_cbranch_execz PADa_39
  s_setprio 2
  s_lshl_b32 s3, s52, 14
  s_and_b32 s3, s3, 0x4000
  v_subrev_u32 v82, s3, v82
  v_subrev_u32 v83, s3, v83
  s_nop 5
  ds_write_b128 v89, v[32:35] offset:0
  ds_write_b128 v89, v[36:39] offset:1024
  ds_write_b128 v89, v[40:43] offset:2048
  ds_write_b128 v89, v[44:47] offset:3072
  ds_write_b128 v90, v[48:51] offset:0
  ds_write_b128 v90, v[52:55] offset:1024
  ds_write_b128 v90, v[56:59] offset:2048
  ds_write_b128 v90, v[60:63] offset:3072
  ds_write_b128 v91, v[64:67] offset:0
  ds_write_b128 v91, v[68:71] offset:1024
  ds_write_b128 v91, v[72:75] offset:2048
  ds_write_b128 v91, v[76:79] offset:3072
  s_waitcnt lgkmcnt(0)
  s_waitcnt vmcnt(0)
  v_mov_b32 v6, 21
  ds_write_b32 v4, v6
  ds_read_b32 v7, v9
  s_waitcnt lgkmcnt(0)
  v_cmp_le_u32 vcc, 4, v7
  s_nop 0
  s_cmp_eq_u64 vcc, -1
  s_cbranch_scc0 sig31_slow
sig31_ok:
  buffer_load_dwordx2 v[86:87], v84, s[36:39], s58 offen sc1
  s_waitcnt vmcnt(0)
  v_cmp_eq_u64 vcc, v[86:87], v[14:15]
  s_nop 0
  s_cmp_eq_u64 vcc, -1
  s_cbranch_scc0 fl32_slow
fl32_ok:
  s_add_u32 s3, s74, 0
  buffer_load_dwordx4 v[128:131], v1, s[36:39], s3 offen offset:0 sc1
  buffer_load_dwordx4 v[132:135], v1, s[36:39], s3 offen offset:1024 sc1
  buffer_load_dwordx4 v[136:139], v1, s[36:39], s3 offen offset:2048 sc1
  buffer_load_dwordx4 v[140:143], v1, s[36:39], s3 offen offset:3072 sc1
  s_add_u32 s3, s74, 4096
  buffer_load_dwordx4 v[144:147], v1, s[36:39], s3 offen offset:0 sc1
  buffer_load_dwordx4 v[148:151], v1, s[36:39], s3 offen offset:1024 sc1
  buffer_load_dwordx4 v[152:155], v1, s[36:39], s3 offen offset:2048 sc1
  buffer_load_dwordx4 v[156:159], v1, s[36:39], s3 offen offset:3072 sc1
  s_add_u32 s3, s74, 8192
  buffer_load_dwordx4 v[160:163], v1, s[36:39], s3 offen offset:0 sc1
  buffer_load_dwordx4 v[164:167], v1, s[36:39], s3 offen offset:1024 sc1
  buffer_load_dwordx4 v[168:171], v1, s[36:39], s3 offen offset:2048 sc1
  buffer_load_dwordx4 v[172:175], v1, s[36:39], s3 offen offset:3072 sc1
  s_add_u32 s3, s74, 12288
  buffer_load_dwordx4 v[176:179], v1, s[36:39], s3 offen offset:0 sc1
  buffer_load_dwordx4 v[180:183], v1, s[36:39], s3 offen offset:1024 sc1
  buffer_load_dwordx4 v[184:187], v1, s[36:39], s3 offen offset:2048 sc1
  buffer_load_dwordx4 v[188:191], v1, s[36:39], s3 offen offset:3072 sc1
  ds_read_b32 v7, v5
  s_waitcnt lgkmcnt(0)
  v_cmp_le_u32 vcc, 21, v7
  s_nop 0
  s_cmp_eq_u64 vcc, -1
  s_cbranch_scc0 sig33_slow
sig33_ok:
  ds_read_b128 v[32:35], v92 offset:0
  ds_read_b128 v[36:39], v92 offset:1024
  ds_read_b128 v[40:43], v92 offset:2048
  ds_read_b128 v[44:47], v92 offset:3072
  ds_read_b128 v[48:51], v92 offset:4096
  ds_read_b128 v[52:55], v92 offset:5120
  ds_read_b128 v[56:59], v92 offset:6144
PADa_36:
  s_cbranch_execz PADa_40
  ds_read_b128 v[60:63], v92 offset:7168
  ds_read_b128 v[64:67], v92 offset:8192
  ds_read_b128 v[68:71], v92 offset:9216
  ds_read_b128 v[72:75], v92 offset:10240
  ds_read_b128 v[76:79], v92 offset:11264
  s_waitcnt lgkmcnt(8)
  v_add_f32 v16, v16, v32
  v_add_f32 v17, v17, v33
  v_add_f32 v18, v18, v34
  v_add_f32 v19, v19, v35
  v_add_f32 v20, v20, v36
  v_add_f32 v21, v21, v37
  v_add_f32 v22, v22, v38
  v_add_f32 v23, v23, v39
  v_add_f32 v24, v24, v40
  v_add_f32 v25, v25, v41
  v_add_f32 v26, v26, v42
  v_add_f32 v27, v27, v43
  v_add_f32 v28, v28, v44
  v_add_f32 v29, v29, v45
  v_add_f32 v30, v30, v46
  v_add_f32 v31, v31, v47
  s_waitcnt lgkmcnt(4)
  ds_read_b64_tr_b16 v[192:193], v82 offset:8192
  ds_read_b64_tr_b16 v[194:195], v82 offset:9216
  ds_read_b64_tr_b16 v[196:197], v83 offset:8192
  ds_read_b64_tr_b16 v[198:199], v83 offset:9216
  v_add_f32 v16, v16, v48
  v_add_f32 v17, v17, v49
  v_add_f32 v18, v18, v50
  v_add_f32 v19, v19, v51
  v_add_f32 v20, v20, v52
  v_add_f32 v21, v21, v53
  v_add_f32 v22, v22, v54
  v_add_f32 v23, v23, v55
  v_add_f32 v24, v24, v56
  v_add_f32 v25, v25, v57
  v_add_f32 v26, v26, v58
  v_add_f32 v27, v27, v59
  v_add_f32 v28, v28, v60
  v_add_f32 v29, v29, v61
  v_add_f32 v30, v30, v62
  v_add_f32 v31, v31, v63
  s_waitcnt lgkmcnt(4)
  ds_read_b64_tr_b16 v[200:201], v82 offset:10240
  ds_read_b64_tr_b16 v[202:203], v82 offset:11264
  ds_read_b64_tr_b16 v[204:205], v83 offset:10240
  ds_read_b64_tr_b16 v[206:207], v83 offset:11264
  v_add_f32 v16, v16, v64
  v_add_f32 v17, v17, v65
  v_add_f32 v18, v18, v66
  v_add_f32 v19, v19, v67
  v_add_f32 v20, v20, v68
  v_add_f32 v21, v21, v69
  v_add_f32 v22, v22, v70
  v_add_f32 v23, v23, v71
  v_add_f32 v24, v24, v72
  v_add_f32 v25, v25, v73
  v_add_f32 v26, v26, v74
  v_add_f32 v27, v27, v75
  v_add_f32 v28, v28, v76
  v_add_f32 v29, v29, v77
  v_add_f32 v30, v30, v78
  v_add_f32 v31, v31, v79
  ds_read_b64_tr_b16 v[208:209], v82 offset:12288
  ds_read_b64_tr_b16 v[210:211], v82 offset:13312
  ds_read_b64_tr_b16 v[212:213], v83 offset:12288
  ds_read_b64_tr_b16 v[214:215], v83 offset:13312
  s_waitcnt lgkmcnt(8)
  s_waitcnt vmcnt(15)
  v_mfma_f32_32x32x16_bf16 v[32:47], v[196:199], v[128:131], 0
  v_mfma_f32_32x32x16_bf16 v[16:31], v[192:195], v[128:131], v[16:31]
  ds_read_b64_tr_b16 v[216:217], v82 offset:14336
  ds_read_b64_tr_b16 v[218:219], v82 offset:15360
  ds_read_b64_tr_b16 v[220:221], v83 offset:14336
  ds_read_b64_tr_b16 v[222:223], v83 offset:15360
  s_waitcnt lgkmcnt(8)
  s_waitcnt vmcnt(14)
  v_mfma_f32_32x32x16_bf16 v[32:47], v[204:207], v[132:135], v[32:47]
  v_mfma_f32_32x32x16_bf16 v[16:31], v[200:203], v[132:135], v[16:31]
  ds_read_b64_tr_b16 v[192:193], v82 offset:0
  ds_read_b64_tr_b16 v[194:195], v82 offset:1024
  ds_read_b64_tr_b16 v[196:197], v83 offset:0
PADa_37:
  s_cbranch_execz PADa_41
  ds_read_b64_tr_b16 v[198:199], v83 offset:1024
  s_waitcnt lgkmcnt(8)
  s_waitcnt vmcnt(13)
  v_mfma_f32_32x32x16_bf16 v[32:47], v[212:215], v[136:139], v[32:47]
  v_mfma_f32_32x32x16_bf16 v[16:31], v[208:211], v[136:139], v[16:31]
  ds_read_b64_tr_b16 v[200:201], v82 offset:2048
  ds_read_b64_tr_b16 v[202:203], v82 offset:3072
  ds_read_b64_tr_b16 v[204:205], v83 offset:2048
  ds_read_b64_tr_b16 v[206:207], v83 offset:3072
  s_waitcnt lgkmcnt(8)
  s_waitcnt vmcnt(12)
  v_mfma_f32_32x32x16_bf16 v[32:47], v[220:223], v[140:143], v[32:47]
  v_mfma_f32_32x32x16_bf16 v[16:31], v[216:219], v[140:143], v[16:31]
  ds_read_b64_tr_b16 v[208:209], v82 offset:4096
  ds_read_b64_tr_b16 v[210:211], v82 offset:5120
  ds_read_b64_tr_b16 v[212:213], v83 offset:4096
  ds_read_b64_tr_b16 v[214:215], v83 offset:5120
  s_waitcnt lgkmcnt(8)
  s_waitcnt vmcnt(11)
  v_mfma_f32_32x32x16_bf16 v[32:47], v[196:199], v[144:147], v[32:47]
  v_mfma_f32_32x32x16_bf16 v[16:31], v[192:195], v[144:147], v[16:31]
  ds_read_b64_tr_b16 v[216:217], v82 offset:6144
  ds_read_b64_tr_b16 v[218:219], v82 offset:7168
  ds_read_b64_tr_b16 v[220:221], v83 offset:6144
  ds_read_b64_tr_b16 v[222:223], v83 offset:7168
  s_waitcnt lgkmcnt(8)
  s_waitcnt vmcnt(10)
  v_mfma_f32_32x32x16_bf16 v[32:47], v[204:207], v[148:151], v[32:47]
  v_mfma_f32_32x32x16_bf16 v[16:31], v[200:203], v[148:151], v[16:31]
  ds_read_b64_tr_b16 v[192:193], v82 offset:24576
  ds_read_b64_tr_b16 v[194:195], v82 offset:25600
  ds_read_b64_tr_b16 v[196:197], v83 offset:24576
  ds_read_b64_tr_b16 v[198:199], v83 offset:25600
  s_waitcnt lgkmcnt(8)
  s_waitcnt vmcnt(9)
  v_mfma_f32_32x32x16_bf16 v[32:47], v[212:215], v[152:155], v[32:47]
  v_mfma_f32_32x32x16_bf16 v[16:31], v[208:211], v[152:155], v[16:31]
  ds_read_b64_tr_b16 v[200:201], v82 offset:26624
  ds_read_b64_tr_b16 v[202:203], v82 offset:27648
  ds_read_b64_tr_b16 v[204:205], v83 offset:26624
  ds_read_b64_tr_b16 v[206:207], v83 offset:27648
  s_waitcnt lgkmcnt(8)
  s_waitcnt vmcnt(8)
  v_mfma_f32_32x32x16_bf16 v[32:47], v[220:223], v[156:159], v[32:47]
  v_mfma_f32_32x32x16_bf16 v[16:31], v[216:219], v[156:159], v[16:31]
  ds_read_b64_tr_b16 v[208:209], v82 offset:28672
  ds_read_b64_tr_b16 v[210:211], v82 offset:29696
  ds_read_b64_tr_b16 v[212:213], v83 offset:28672
  ds_read_b64_tr_b16 v[214:215], v83 offset:29696
  s_waitcnt lgkmcnt(8)
  s_waitcnt vmcnt(7)
  v_mfma_f32_32x32x16_bf16 v[32:47], v[196:199], v[160:163], v[32:47]
  v_mfma_f32_32x32x16_bf16 v[16:31], v[192:195], v[160:163], v[16:31]
  ds_read_b64_tr_b16 v[216:217], v82 offset:30720
  ds_read_b64_tr_b16 v[218:219], v82 offset:31744
  ds_read_b64_tr_b16 v[220:221], v83 offset:30720
  ds_read_b64_tr_b16 v[222:223], v83 offset:31744
  s_waitcnt lgkmcnt(8)
  s_waitcnt vmcnt(6)
  v_mfma_f32_32x32x16_bf16 v[32:47], v[204:207], v[164:167], v[32:47]
  v_mfma_f32_32x32x16_bf16 v[16:31], v[200:203], v[164:167], v[16:31]
  ds_read_b64_tr_b16 v[192:193], v82 offset:16384
  ds_read_b64_tr_b16 v[194:195], v82 offset:17408
PADa_38:
  s_cbranch_execz PADa_42
  ds_read_b64_tr_b16 v[196:197], v83 offset:16384
  ds_read_b64_tr_b16 v[198:199], v83 offset:17408
  s_waitcnt lgkmcnt(8)
  s_waitcnt vmcnt(5)
  v_mfma_f32_32x32x16_bf16 v[32:47], v[212:215], v[168:171], v[32:47]
  v_mfma_f32_32x32x16_bf16 v[16:31], v[208:211], v[168:171], v[16:31]
  ds_read_b64_tr_b16 v[200:201], v82 offset:18432
  ds_read_b64_tr_b16 v[202:203], v82 offset:19456
  ds_read_b64_tr_b16 v[204:205], v83 offset:18432
  ds_read_b64_tr_b16 v[206:207], v83 offset:19456
  s_waitcnt lgkmcnt(8)
  s_waitcnt vmcnt(4)
  v_mfma_f32_32x32x16_bf16 v[32:47], v[220:223], v[172:175], v[32:47]
  v_mfma_f32_32x32x16_bf16 v[16:31], v[216:219], v[172:175], v[16:31]
  ds_read_b64_tr_b16 v[208:209], v82 offset:20480
  ds_read_b64_tr_b16 v[210:211], v82 offset:21504
  ds_read_b64_tr_b16 v[212:213], v83 offset:20480
  ds_read_b64_tr_b16 v[214:215], v83 offset:21504
  s_waitcnt lgkmcnt(8)
  s_waitcnt vmcnt(3)
  v_mfma_f32_32x32x16_bf16 v[32:47], v[196:199], v[176:179], v[32:47]
  v_mfma_f32_32x32x16_bf16 v[16:31], v[192:195], v[176:179], v[16:31]
  ds_read_b64_tr_b16 v[216:217], v82 offset:22528
  ds_read_b64_tr_b16 v[218:219], v82 offset:23552
  ds_read_b64_tr_b16 v[220:221], v83 offset:22528
  ds_read_b64_tr_b16 v[222:223], v83 offset:23552
  s_waitcnt lgkmcnt(8)
  s_waitcnt vmcnt(2)
  v_mfma_f32_32x32x16_bf16 v[32:47], v[204:207], v[180:183], v[32:47]
  v_mfma_f32_32x32x16_bf16 v[16:31], v[200:203], v[180:183], v[16:31]
  s_waitcnt lgkmcnt(4)
  s_waitcnt vmcnt(1)
  v_mfma_f32_32x32x16_bf16 v[32:47], v[212:215], v[184:187], v[32:47]
  v_mfma_f32_32x32x16_bf16 v[16:31], v[208:211], v[184:187], v[16:31]
  s_waitcnt lgkmcnt(0)
  s_waitcnt vmcnt(0)
  v_mfma_f32_32x32x16_bf16 v[32:47], v[220:223], v[188:191], v[32:47]
  v_mfma_f32_32x32x16_bf16 v[16:31], v[216:219], v[188:191], v[16:31]
  v_mov_b32 v6, 22
  v_xor_b32 v86, 0x2000, v93
  s_nop 8
  ds_write_b128 v93, v[32:35] offset:0
  ds_write_b128 v93, v[36:39] offset:1024
  ds_write_b128 v93, v[40:43] offset:2048
  ds_write_b128 v93, v[44:47] offset:3072
  s_waitcnt lgkmcnt(0)
  ds_write_b32 v4, v6
  ds_read_b32 v7, v94
  s_waitcnt lgkmcnt(0)
  v_cmp_le_u32 vcc, 22, v7
  s_nop 0
  s_cmp_eq_u64 vcc, -1
  s_cbranch_scc0 sig34_slow
sig34_ok:
  ds_read_b128 v[48:51], v86 offset:0
  ds_read_b128 v[52:55], v86 offset:1024
  ds_read_b128 v[56:59], v86 offset:2048
  ds_read_b128 v[60:63], v86 offset:3072
  s_waitcnt lgkmcnt(3)
  v_add_f32 v16, v16, v48
  v_add_f32 v17, v17, v49
  v_add_f32 v18, v18, v50
  v_add_f32 v19, v19, v51
  s_waitcnt lgkmcnt(2)
  v_add_f32 v20, v20, v52
  v_add_f32 v21, v21, v53
  v_add_f32 v22, v22, v54
  v_add_f32 v23, v23, v55
  s_waitcnt lgkmcnt(1)
  v_add_f32 v24, v24, v56
  v_add_f32 v25, v25, v57
  v_add_f32 v26, v26, v58
  v_add_f32 v27, v27, v59
  s_waitcnt lgkmcnt(0)
  v_add_f32 v28, v28, v60
PADa_39:
  s_cbranch_execz RETa
  v_add_f32 v29, v29, v61
  v_add_f32 v30, v30, v62
  v_add_f32 v31, v31, v63
  v_cvt_pk_bf16_f32 v96, v16, v17
  v_cvt_pk_bf16_f32 v97, v18, v19
  v_cvt_pk_bf16_f32 v98, v20, v21
  v_cvt_pk_bf16_f32 v99, v22, v23
  v_cvt_pk_bf16_f32 v100, v24, v25
  v_cvt_pk_bf16_f32 v101, v26, v27
  v_cvt_pk_bf16_f32 v102, v28, v29
  v_cvt_pk_bf16_f32 v103, v30, v31
  s_nop 1
  v_permlane32_swap_b32 v96, v98
  v_permlane32_swap_b32 v97, v99
  v_permlane32_swap_b32 v100, v102
  v_permlane32_swap_b32 v101, v103
  buffer_store_dwordx4 v[96:99], v13, s[48:51], 0 offen offset:0 nt
  buffer_store_dwordx4 v[100:103], v13, s[48:51], 0 offen offset:32 nt
  s_endpgm
sig3_slow:
  ds_read_b32 v13, v12
  s_waitcnt lgkmcnt(0)
  v_cmp_le_u32 vcc, 2, v13
  s_cmp_eq_u32 s70, 0
  s_cbranch_scc1 sig3_ok
  s_sub_u32 s70, s70, 1
  s_cmp_eq_u64 vcc, -1
  s_cbranch_scc0 sig3_slow
  s_branch sig3_ok
sig5_slow:
  ds_read_b32 v13, v12
  s_waitcnt lgkmcnt(0)
  v_cmp_le_u32 vcc, 3, v13
  s_cmp_eq_u32 s70, 0
  s_cbranch_scc1 sig5_ok
  s_sub_u32 s70, s70, 1
  s_cmp_eq_u64 vcc, -1
  s_cbranch_scc0 sig5_slow
  s_branch sig5_ok
sig6_slow:
  ds_read_b32 v13, v12
  s_waitcnt lgkmcnt(0)
  v_cmp_le_u32 vcc, 6, v13
  s_cmp_eq_u32 s70, 0
  s_cbranch_scc1 sig6_ok
  s_sub_u32 s70, s70, 1
  s_cmp_eq_u64 vcc, -1
  s_cbranch_scc0 sig6_slow
  s_branch sig6_ok
sig7_slow:
  ds_read_b32 v11, v9
  s_waitcnt lgkmcnt(0)
  v_cmp_le_u32 vcc, 3, v11
  s_cmp_eq_u32 s70, 0
  s_cbranch_scc1 sig7_ok
  s_sub_u32 s70, s70, 1
  s_cmp_eq_u64 vcc, -1
  s_cbranch_scc0 sig7_slow
  s_branch sig7_ok
sig10_slow:
  ds_read_b32 v7, v5
  s_waitcnt lgkmcnt(0)
  v_cmp_le_u32 vcc, 1, v7
  s_cmp_eq_u32 s70, 0
  s_cbranch_scc1 sig10_ok
  s_sub_u32 s70, s70, 1
  s_cmp_eq_u64 vcc, -1
  s_cbranch_scc0 sig10_slow
  s_branch sig10_ok
sig11_slow:
  ds_read_b32 v7, v72
  s_waitcnt lgkmcnt(0)
  v_cmp_le_u32 vcc, 1, v7
  s_cmp_eq_u32 s70, 0
  s_cbranch_scc1 sig11_ok
  s_sub_u32 s70, s70, 1
  s_cmp_eq_u64 vcc, -1
  s_cbranch_scc0 sig11_slow
  s_branch sig11_ok
sig12_slow:
  ds_read_b32 v7, v72
  s_waitcnt lgkmcnt(0)
  v_cmp_le_u32 vcc, 2, v7
  s_cmp_eq_u32 s70, 0
  s_cbranch_scc1 sig12_ok
  s_sub_u32 s70, s70, 1
  s_cmp_eq_u64 vcc, -1
  s_cbranch_scc0 sig12_slow
  s_branch sig12_ok
sig13_slow:
  ds_read_b32 v7, v5
  s_waitcnt lgkmcnt(0)
  v_cmp_le_u32 vcc, 5, v7
  s_cmp_eq_u32 s70, 0
  s_cbranch_scc1 sig13_ok
  s_sub_u32 s70, s70, 1
  s_cmp_eq_u64 vcc, -1
  s_cbranch_scc0 sig13_slow
  s_branch sig13_ok
sig14_slow:
  ds_read_b32 v7, v5
  s_waitcnt lgkmcnt(0)
  v_cmp_le_u32 vcc, 6, v7
  s_cmp_eq_u32 s70, 0
  s_cbranch_scc1 sig14_ok
  s_sub_u32 s70, s70, 1
  s_cmp_eq_u64 vcc, -1
  s_cbranch_scc0 sig14_slow
  s_branch sig14_ok
sig15_slow:
  ds_read_b32 v7, v5
  s_waitcnt lgkmcnt(0)
  v_cmp_le_u32 vcc, 7, v7
  s_cmp_eq_u32 s70, 0
  s_cbranch_scc1 sig15_ok
  s_sub_u32 s70, s70, 1
  s_cmp_eq_u64 vcc, -1
  s_cbranch_scc0 sig15_slow
  s_branch sig15_ok
sig16_slow:
  ds_read_b32 v7, v5
  s_waitcnt lgkmcnt(0)
  v_cmp_le_u32 vcc, 8, v7
  s_cmp_eq_u32 s70, 0
  s_cbranch_scc1 sig16_ok
  s_sub_u32 s70, s70, 1
  s_cmp_eq_u64 vcc, -1
  s_cbranch_scc0 sig16_slow
  s_branch sig16_ok
sig17_slow:
  ds_read_b32 v7, v5
  s_waitcnt lgkmcnt(0)
  v_cmp_le_u32 vcc, 9, v7
  s_cmp_eq_u32 s70, 0
  s_cbranch_scc1 sig17_ok
  s_sub_u32 s70, s70, 1
  s_cmp_eq_u64 vcc, -1
  s_cbranch_scc0 sig17_slow
  s_branch sig17_ok
sig18_slow:
  ds_read_b32 v7, v5
  s_waitcnt lgkmcnt(0)
  v_cmp_le_u32 vcc, 10, v7
  s_cmp_eq_u32 s70, 0
  s_cbranch_scc1 sig18_ok
  s_sub_u32 s70, s70, 1
  s_cmp_eq_u64 vcc, -1
  s_cbranch_scc0 sig18_slow
  s_branch sig18_ok
sig19_slow:
  ds_read_b32 v7, v5
  s_waitcnt lgkmcnt(0)
  v_cmp_le_u32 vcc, 11, v7
  s_cmp_eq_u32 s70, 0
  s_cbranch_scc1 sig19_ok
  s_sub_u32 s70, s70, 1
  s_cmp_eq_u64 vcc, -1
  s_cbranch_scc0 sig19_slow
  s_branch sig19_ok
sig20_slow:
  ds_read_b32 v7, v5
  s_waitcnt lgkmcnt(0)
  v_cmp_le_u32 vcc, 12, v7
  s_cmp_eq_u32 s70, 0
  s_cbranch_scc1 sig20_ok
  s_sub_u32 s70, s70, 1
  s_cmp_eq_u64 vcc, -1
  s_cbranch_scc0 sig20_slow
  s_branch sig20_ok
sig21_slow:
  ds_read_b32 v7, v5
  s_waitcnt lgkmcnt(0)
  v_cmp_le_u32 vcc, 13, v7
  s_cmp_eq_u32 s70, 0
  s_cbranch_scc1 sig21_ok
  s_sub_u32 s70, s70, 1
  s_cmp_eq_u64 vcc, -1
  s_cbranch_scc0 sig21_slow
  s_branch sig21_ok
sig22_slow:
  ds_read_b32 v7, v5
  s_waitcnt lgkmcnt(0)
  v_cmp_le_u32 vcc, 14, v7
  s_cmp_eq_u32 s70, 0
  s_cbranch_scc1 sig22_ok
  s_sub_u32 s70, s70, 1
  s_cmp_eq_u64 vcc, -1
  s_cbranch_scc0 sig22_slow
  s_branch sig22_ok
sig23_slow:
  ds_read_b32 v7, v5
  s_waitcnt lgkmcnt(0)
  v_cmp_le_u32 vcc, 15, v7
  s_cmp_eq_u32 s70, 0
  s_cbranch_scc1 sig23_ok
  s_sub_u32 s70, s70, 1
  s_cmp_eq_u64 vcc, -1
  s_cbranch_scc0 sig23_slow
  s_branch sig23_ok
sig24_slow:
  ds_read_b32 v7, v5
  s_waitcnt lgkmcnt(0)
  v_cmp_le_u32 vcc, 16, v7
  s_cmp_eq_u32 s70, 0
  s_cbranch_scc1 sig24_ok
  s_sub_u32 s70, s70, 1
  s_cmp_eq_u64 vcc, -1
  s_cbranch_scc0 sig24_slow
  s_branch sig24_ok
sig25_slow:
  ds_read_b32 v7, v5
  s_waitcnt lgkmcnt(0)
  v_cmp_le_u32 vcc, 17, v7
  s_cmp_eq_u32 s70, 0
  s_cbranch_scc1 sig25_ok
  s_sub_u32 s70, s70, 1
  s_cmp_eq_u64 vcc, -1
  s_cbranch_scc0 sig25_slow
  s_branch sig25_ok
fl26_slow:
  buffer_load_dwordx2 v[86:87], v84, s[36:39], s58 offen sc1
  s_waitcnt vmcnt(0)
  v_cmp_eq_u64 vcc, v[86:87], v[14:15]
  s_cmp_eq_u32 s70, 0
  s_cbranch_scc1 fl26_ok
  s_sub_u32 s70, s70, 1
  s_cmp_eq_u64 vcc, -1
  s_cbranch_scc0 fl26_slow
  s_branch fl26_ok
sig27_slow:
  ds_read_b32 v7, v5
  s_waitcnt lgkmcnt(0)
  v_cmp_le_u32 vcc, 18, v7
  s_cmp_eq_u32 s70, 0
  s_cbranch_scc1 sig27_ok
  s_sub_u32 s70, s70, 1
  s_cmp_eq_u64 vcc, -1
  s_cbranch_scc0 sig27_slow
  s_branch sig27_ok
sig28_slow:
  ds_read_b32 v7, v5
  s_waitcnt lgkmcnt(0)
  v_cmp_le_u32 vcc, 19, v7
  s_cmp_eq_u32 s70, 0
  s_cbranch_scc1 sig28_ok
  s_sub_u32 s70, s70, 1
  s_cmp_eq_u64 vcc, -1
  s_cbranch_scc0 sig28_slow
  s_branch sig28_ok
sig29_slow:
  ds_read_b32 v7, v5
  s_waitcnt lgkmcnt(0)
  v_cmp_le_u32 vcc, 20, v7
  s_cmp_eq_u32 s70, 0
  s_cbranch_scc1 sig29_ok
  s_sub_u32 s70, s70, 1
  s_cmp_eq_u64 vcc, -1
  s_cbranch_scc0 sig29_slow
  s_branch sig29_ok
fl30_slow:
  buffer_load_dwordx2 v[86:87], v84, s[36:39], s58 offen sc1
  s_waitcnt vmcnt(0)
  v_cmp_eq_u64 vcc, v[86:87], v[14:15]
  s_cmp_eq_u32 s70, 0
  s_cbranch_scc1 fl30_ok
  s_sub_u32 s70, s70, 1
  s_cmp_eq_u64 vcc, -1
  s_cbranch_scc0 fl30_slow
  s_branch fl30_ok
sig31_slow:
  ds_read_b32 v7, v9
  s_waitcnt lgkmcnt(0)
  v_cmp_le_u32 vcc, 4, v7
  s_cmp_eq_u32 s70, 0
  s_cbranch_scc1 sig31_ok
  s_sub_u32 s70, s70, 1
  s_cmp_eq_u64 vcc, -1
  s_cbranch_scc0 sig31_slow
  s_branch sig31_ok
fl32_slow:
  buffer_load_dwordx2 v[86:87], v84, s[36:39], s58 offen sc1
  s_waitcnt vmcnt(0)
  v_cmp_eq_u64 vcc, v[86:87], v[14:15]
  s_cmp_eq_u32 s70, 0
  s_cbranch_scc1 fl32_ok
  s_sub_u32 s70, s70, 1
  s_cmp_eq_u64 vcc, -1
  s_cbranch_scc0 fl32_slow
  s_branch fl32_ok
sig33_slow:
  ds_read_b32 v7, v5
  s_waitcnt lgkmcnt(0)
  v_cmp_le_u32 vcc, 21, v7
  s_cmp_eq_u32 s70, 0
  s_cbranch_scc1 sig33_ok
  s_sub_u32 s70, s70, 1
  s_cmp_eq_u64 vcc, -1
  s_cbranch_scc0 sig33_slow
  s_branch sig33_ok
sig34_slow:
  ds_read_b32 v7, v94
  s_waitcnt lgkmcnt(0)
  v_cmp_le_u32 vcc, 22, v7
  s_cmp_eq_u32 s70, 0
  s_cbranch_scc1 sig34_ok
  s_sub_u32 s70, s70, 1
  s_cmp_eq_u64 vcc, -1
  s_cbranch_scc0 sig34_slow
  s_branch sig34_ok
L_exit:
  s_endpgm
L_end:
.section .rodata,"a"
.p2align 6
.amdhsa_kernel parallel_sum__softmax_full_mha__glu_gated_reglu__prompt_kernel
  .amdhsa_next_free_vgpr 256
  .amdhsa_next_free_sgpr 96
  .amdhsa_accum_offset 256
  .amdhsa_group_segment_fixed_size 0
  .amdhsa_kernarg_size 80
  .amdhsa_user_sgpr_count 2
  .amdhsa_user_sgpr_kernarg_segment_ptr 1
  .amdhsa_system_sgpr_workgroup_id_x 1
  .amdhsa_float_denorm_mode_32 3
.end_amdhsa_kernel
```
